```python
import torch

def _softmax(x, axis=-1):
    return torch.softmax(x, dim=axis)
def _gelu(x):
    return torch.nn.functional.gelu(x, approximate="tanh")
def _silu(x):
    return torch.nn.functional.silu(x)
def _sigmoid(x):
    return torch.sigmoid(x)
def _layernorm(x, axis=-1, eps=1e-5):
    m = x.mean(dim=axis, keepdim=True)
    v = x.var(dim=axis, keepdim=True, unbiased=False)
    return (x - m) / torch.sqrt(v + eps)
def _scatter_add(tgt, idx, src, axis=0):
    return tgt.clone().index_add_(axis, idx, src)
def _segment_sum(src, seg, n):
    out = torch.zeros((n,) + src.shape[1:], dtype=src.dtype)
    return out.index_add_(0, seg, src)
def _pad(x, pw):
    flat = tuple(v for pair in reversed(pw) for v in pair)
    return torch.nn.functional.pad(x, flat)

kernel_name = 'concat_heads__gqa_block_cached__mha_block_cached__near_ridge'

def setup_inputs():

    _w = (lambda a: (lambda t: t.to(torch.bfloat16) if t.is_floating_point() else t)(torch.as_tensor(a)))
    def _A_setup():
        B, Sq, D = 16, 32, 576
        Hq, Hkv, Sk, Dh = 32, 16, 32, 128
        assert Hq % Hkv == 0, (Hq, Hkv)
        return {
            "x": _w((lambda *s: torch.randn(*s, dtype=torch.bfloat16) * 0.8)(B, Sq, D)),
            "k_cache": _w((lambda *s: torch.randn(*s, dtype=torch.bfloat16) * 0.8)(B, Hkv, Sk, Dh)),
            "v_cache": _w((lambda *s: torch.randn(*s, dtype=torch.bfloat16) * 0.05)(B, Hkv, Sk, Dh)),
            "wq": _w((lambda *s: torch.randn(*s, dtype=torch.bfloat16) * 0.8)(D, Hq * Dh) * (D ** -0.5)),
            "wo": _w((lambda *s: torch.randn(*s, dtype=torch.bfloat16) * 0.05)(Hq * Dh, D) * ((Hq * Dh) ** -0.5)),
        }
    _A_in = _A_setup()

    def _B_setup():
        B, Sq, D = 16, 32, 576
        H, Sk, Dh = 32, 32, 128
        return {
            "x": _w((lambda *s: torch.randn(*s, dtype=torch.bfloat16) * 0.8)(B, Sq, D)),
            "k_cache": _w((lambda *s: torch.randn(*s, dtype=torch.bfloat16) * 0.8)(B, H, Sk, Dh)),
            "v_cache": _w((lambda *s: torch.randn(*s, dtype=torch.bfloat16) * 0.05)(B, H, Sk, Dh)),
            "wq": _w((lambda *s: torch.randn(*s, dtype=torch.bfloat16) * 0.8)(D, H * Dh) * (D ** -0.5)),
            "wo": _w((lambda *s: torch.randn(*s, dtype=torch.bfloat16) * 0.05)(H * Dh, D) * ((H * Dh) ** -0.5)),
        }
    _B_in = _B_setup()

    return {
        "A_x": _A_in["x"],
        "A_k_cache": _A_in["k_cache"],
        "A_v_cache": _A_in["v_cache"],
        "A_wq": _A_in["wq"],
        "A_wo": _A_in["wo"],
        "B_x": _B_in["x"],
        "B_k_cache": _B_in["k_cache"],
        "B_v_cache": _B_in["v_cache"],
        "B_wq": _B_in["wq"],
        "B_wo": _B_in["wo"],
    }

def reference(A_x, A_k_cache, A_v_cache, A_wq, A_wo, B_x, B_k_cache, B_v_cache, B_wq, B_wo):
    def _A_ref(x, k_cache, v_cache, wq, wo):
        B, Sq, D = x.shape
        Hq, Dh = 32, 128
        Hkv = k_cache.shape[1]
        rep = Hq // Hkv
        q = (lambda x, *d: x.permute(*d))((x @ wq).reshape(B, Sq, Hq, Dh), 0, 2, 1, 3)
        k = (lambda x, n, axis: torch.repeat_interleave(x, n, dim=axis))(k_cache, rep, axis=1)
        v = (lambda x, n, axis: torch.repeat_interleave(x, n, dim=axis))(v_cache, rep, axis=1)
        scores = torch.einsum("bhqd,bhkd->bhqk", q, k) * (Dh ** -0.5)
        p = _softmax(scores, axis=-1)
        o = torch.einsum("bhqk,bhkd->bhqd", p, v)
        return (lambda x, *d: x.permute(*d))(o, 0, 2, 1, 3).reshape(B, Sq, Hq * Dh) @ wo

    def _B_ref(x, k_cache, v_cache, wq, wo):
        B, Sq, D = x.shape
        H, Dh = 32, 128
        q = (lambda x, *d: x.permute(*d))((x @ wq).reshape(B, Sq, H, Dh), 0, 2, 1, 3)
        scores = torch.einsum("bhqd,bhkd->bhqk", q, k_cache) * (Dh ** -0.5)
        p = _softmax(scores, axis=-1)
        o = torch.einsum("bhqk,bhkd->bhqd", p, v_cache)
        return (lambda x, *d: x.permute(*d))(o, 0, 2, 1, 3).reshape(B, Sq, H * Dh) @ wo

    a = _A_ref(A_x, A_k_cache, A_v_cache, A_wq, A_wo)
    b = _B_ref(B_x, B_k_cache, B_v_cache, B_wq, B_wo)
    return torch.concatenate([a, b], axis=-1)
```

```asm
; @launch grid=(256,1,1) block=(512,1,1) lds=155904
.amdgcn_target "amdgcn-amd-amdhsa--gfx950"
.text
.globl concat_heads__gqa_block_cached__mha_block_cached__near_ridge_kernel
.p2align 8
.type concat_heads__gqa_block_cached__mha_block_cached__near_ridge_kernel,@function
concat_heads__gqa_block_cached__mha_block_cached__near_ridge_kernel:
    s_load_dwordx16 s[36:51], s[0:1], 0
    s_load_dwordx8 s[52:59], s[0:1], 64
    s_load_dwordx2 s[60:61], s[0:1], 96
    v_lshrrev_b32 v1, 6, v0
    s_cmp_ge_u32 s2, 256
    s_cbranch_scc1 L_end
    v_readfirstlane_b32 s71, v1
    s_and_b32 s70, s2, 7
    v_and_b32 v1, 63, v0
    s_lshr_b32 s63, s70, 2
    s_and_b32 s64, s70, 3
    s_bfe_u32 s65, s2, 0x20003
    s_lshr_b32 s66, s2, 5
    s_and_b32 s62, s71, 3
    s_lshl_b32 s67, s64, 3
    s_add_u32 s67, s67, s66
    s_lshl_b32 s68, s65, 2
    s_add_u32 s68, s68, s62
    s_and_b32 s80, s66, 3
    s_lshr_b32 s81, s66, 2
    s_lshl_b32 s69, s64, 1
    s_add_u32 s69, s69, s81
    s_lshl_b32 s82, s62, 12
    s_lshl_b32 s83, s62, 13
    s_cmp_ge_u32 s71, 4
    s_cbranch_scc1 L_loader
    s_getpc_b64 s[98:99]
L_pc:
    s_lshr_b32 s70, s2, 3
    s_mul_i32 s70, s70, 768
    v_min_u32 v26, 5, v1
    v_lshlrev_b32 v26, 7, v26
    v_add_u32 v26, s70, v26
    v_min_u32 v26, L_fin-L_pc-4, v26
    s_cmp_lg_u32 s62, 0
    s_cbranch_scc1 L_nopf
    global_load_dword v33, v26, s[98:99]
L_nopf:
    v_and_b32 v26, 31, v1
    v_lshrrev_b32 v27, 5, v1
    v_bfe_u32 v28, v1, 1, 3
    v_xor_b32 v28, v28, v27
    v_lshlrev_b32 v28, 4, v28
    v_lshl_add_u32 v28, v26, 7, v28
    v_add_u32 v2, s82, v28
    v_xor_b32 v3, 32, v2
    v_xor_b32 v4, 64, v2
    v_xor_b32 v5, 96, v2
    v_bfe_u32 v26, v1, 2, 2
    v_lshl_add_u32 v28, v27, 3, v26
    v_lshlrev_b32 v28, 8, v28
    v_lshl_add_u32 v28, v26, 6, v28
    v_bfe_u32 v29, v1, 4, 1
    v_lshl_add_u32 v28, v29, 5, v28
    v_and_b32 v29, 1, v1
    v_lshl_add_u32 v28, v29, 4, v28
    v_bfe_u32 v29, v1, 1, 1
    v_lshl_add_u32 v28, v29, 3, v28
    v_add_u32 v10, 16384, v28
    v_xor_b32 v11, 64, v10
    v_xor_b32 v12, 128, v10
    v_xor_b32 v13, 192, v10
    s_branch L_compute
L_loader:
    v_lshrrev_b32 v27, 4, v1
    s_lshl_b32 s70, s62, 4
    v_add_u32 v29, s70, v27
    v_lshlrev_b32 v29, 13, v29
    v_and_b32 v30, 15, v1
    v_lshlrev_b32 v31, 2, v27
    v_xor_b32 v30, v30, v31
    v_lshl_add_u32 v6, v30, 4, v29
    v_add_u32 v7, 31744, v6
    v_add_u32 v8, 63488, v6
    v_add_u32 v9, 95232, v6
    v_lshrrev_b32 v26, 3, v1
    v_and_b32 v28, 7, v1
    s_lshl_b32 s70, s62, 5
    v_add_u32 v29, s70, v26
    v_mul_u32_u24 v29, 1152, v29
    v_xor_b32 v28, v28, v27
    v_lshl_add_u32 v2, v28, 4, v29
    v_xor_b32 v28, 4, v28
    v_lshl_add_u32 v3, v28, 4, v29
    v_add_u32 v3, 8192, v3
    v_add_u32 v4, 16384, v2
    v_add_u32 v5, 16384, v3
    s_mul_i32 s74, s65, 147456
    s_lshl_b32 s75, s67, 8
    s_sub_u32 s70, s65, s66
    s_and_b32 s70, s70, 3
    s_mov_b32 s98, 2253603344
    s_mov_b32 s99, 7
    s_cmp_eq_u32 s70, 1
    s_cselect_b32 s98, 1984246273, s98
    s_cselect_b32 s99, 8, s99
    s_cmp_eq_u32 s70, 2
    s_cselect_b32 s98, 1969500448, s98
    s_cselect_b32 s99, 8, s99
    s_cmp_eq_u32 s70, 3
    s_cselect_b32 s98, 1733567248, s98
    s_cselect_b32 s99, 8, s99
    s_mov_b32 s10, 589824
    s_mov_b32 s11, 0x20000
    s_mov_b32 s14, 4718592
    s_mov_b32 s15, 0x20000
    s_cmp_eq_u32 s63, 0
    s_waitcnt lgkmcnt(0)
    s_cselect_b32 s12, s42, s52
    s_cselect_b32 s13, s43, s53
    s_cselect_b32 s8, s36, s46
    s_cselect_b32 s9, s37, s47
    s_and_b32 s13, s13, 0xffff
    s_and_b32 s9, s9, 0xffff
    s_bfe_u32 s5, s98, 262144
    s_add_u32 m0, s82, 16384
    s_lshl_b32 s72, s5, 19
    s_add_u32 s72, s72, s75
    buffer_load_dwordx4 v6, s[12:15], s72 offen offset:0 lds
    buffer_load_dwordx4 v7, s[12:15], s72 offen offset:1024 lds
    buffer_load_dwordx4 v8, s[12:15], s72 offen offset:2048 lds
    buffer_load_dwordx4 v9, s[12:15], s72 offen offset:3072 lds
    s_add_u32 m0, s82, 0
    s_lshl_b32 s72, s5, 7
    s_add_u32 s72, s72, s74
    buffer_load_dwordx4 v2, s[8:11], s72 offen offset:0 lds
    buffer_load_dwordx4 v3, s[8:11], s72 offen offset:1024 lds
    buffer_load_dwordx4 v4, s[8:11], s72 offen offset:2048 lds
    buffer_load_dwordx4 v5, s[8:11], s72 offen offset:3072 lds
    s_bfe_u32 s5, s98, 262148
    s_add_u32 m0, s82, 53248
    s_lshl_b32 s72, s5, 19
    s_add_u32 s72, s72, s75
    buffer_load_dwordx4 v6, s[12:15], s72 offen offset:0 lds
    buffer_load_dwordx4 v7, s[12:15], s72 offen offset:1024 lds
    buffer_load_dwordx4 v8, s[12:15], s72 offen offset:2048 lds
    buffer_load_dwordx4 v9, s[12:15], s72 offen offset:3072 lds
    s_add_u32 m0, s82, 36864
    s_lshl_b32 s72, s5, 7
    s_add_u32 s72, s72, s74
    buffer_load_dwordx4 v2, s[8:11], s72 offen offset:0 lds
    buffer_load_dwordx4 v3, s[8:11], s72 offen offset:1024 lds
    buffer_load_dwordx4 v4, s[8:11], s72 offen offset:2048 lds
    buffer_load_dwordx4 v5, s[8:11], s72 offen offset:3072 lds
    s_mov_b32 s73, 4194304
    s_cmp_eq_u32 s63, 0
    s_cselect_b32 s16, s38, s48
    s_cselect_b32 s17, s39, s49
    s_cselect_b32 s18, 2097152, s73
    s_mov_b32 s19, 0x20000
    s_cselect_b32 s24, s40, s50
    s_cselect_b32 s25, s41, s51
    s_cselect_b32 s26, 2097152, s73
    s_mov_b32 s27, 0x20000
    s_cselect_b32 s28, s44, s54
    s_cselect_b32 s29, s45, s55
    s_mov_b32 s30, 4718592
    s_mov_b32 s31, 0x20000
    s_and_b32 s17, s17, 0xffff
    s_and_b32 s25, s25, 0xffff
    s_and_b32 s29, s29, 0xffff
    v_lshrrev_b32 v26, 4, v1
    v_and_b32 v27, 15, v1
    v_add_u32 v10, 0, v26
    v_xor_b32 v10, v10, v27
    v_lshlrev_b32 v10, 4, v10
    v_lshl_add_u32 v10, v26, 8, v10
    v_add_u32 v11, 4, v26
    v_xor_b32 v11, v11, v27
    v_lshlrev_b32 v11, 4, v11
    v_lshl_add_u32 v11, v26, 8, v11
    v_add_u32 v12, 8, v26
    v_xor_b32 v12, v12, v27
    v_lshlrev_b32 v12, 4, v12
    v_lshl_add_u32 v12, v26, 8, v12
    v_add_u32 v13, 12, v26
    v_xor_b32 v13, v13, v27
    v_lshlrev_b32 v13, 4, v13
    v_lshl_add_u32 v13, v26, 8, v13
    s_lshl_b32 s70, s68, 4
    s_lshr_b32 s71, s67, 1
    s_add_u32 s70, s70, s71
    s_lshl_b32 s71, s68, 5
    s_add_u32 s71, s71, s67
    s_cmp_eq_u32 s63, 0
    s_cselect_b32 s76, s70, s71
    s_lshl_b32 s76, s76, 13
    s_mov_b32 s20, s60
    s_and_b32 s21, s61, 0xffff
    s_mov_b32 s22, 17825792
    s_mov_b32 s23, 0x20000
    s_mov_b32 s32, s56
    s_and_b32 s33, s57, 0xffff
    s_mov_b32 s34, 1179648
    s_mov_b32 s35, 0x20000
    s_waitcnt vmcnt(8)
    s_barrier
    s_bfe_u32 s5, s98, 262152
    s_add_u32 m0, s82, 90112
    s_lshl_b32 s72, s5, 19
    s_add_u32 s72, s72, s75
    buffer_load_dwordx4 v6, s[12:15], s72 offen offset:0 lds
    buffer_load_dwordx4 v7, s[12:15], s72 offen offset:1024 lds
    buffer_load_dwordx4 v8, s[12:15], s72 offen offset:2048 lds
    buffer_load_dwordx4 v9, s[12:15], s72 offen offset:3072 lds
    s_add_u32 m0, s82, 73728
    s_lshl_b32 s72, s5, 7
    s_add_u32 s72, s72, s74
    buffer_load_dwordx4 v2, s[8:11], s72 offen offset:0 lds
    buffer_load_dwordx4 v3, s[8:11], s72 offen offset:1024 lds
    buffer_load_dwordx4 v4, s[8:11], s72 offen offset:2048 lds
    buffer_load_dwordx4 v5, s[8:11], s72 offen offset:3072 lds
    s_add_u32 m0, s83, 110592
    s_mov_b32 s72, s76
    buffer_load_dwordx4 v10, s[16:19], s72 offen offset:0 lds
    buffer_load_dwordx4 v11, s[16:19], s72 offen offset:1024 lds
    buffer_load_dwordx4 v12, s[16:19], s72 offen offset:2048 lds
    buffer_load_dwordx4 v13, s[16:19], s72 offen offset:3072 lds
    s_add_u32 m0, s83, 114688
    s_add_u32 s72, s76, 4096
    buffer_load_dwordx4 v10, s[16:19], s72 offen offset:0 lds
    buffer_load_dwordx4 v11, s[16:19], s72 offen offset:1024 lds
    buffer_load_dwordx4 v12, s[16:19], s72 offen offset:2048 lds
    buffer_load_dwordx4 v13, s[16:19], s72 offen offset:3072 lds
    s_waitcnt vmcnt(16)
    s_barrier
    s_bfe_u32 s5, s98, 262156
    s_add_u32 m0, s82, 16384
    s_lshl_b32 s72, s5, 19
    s_add_u32 s72, s72, s75
    buffer_load_dwordx4 v6, s[12:15], s72 offen offset:0 lds
    buffer_load_dwordx4 v7, s[12:15], s72 offen offset:1024 lds
    buffer_load_dwordx4 v8, s[12:15], s72 offen offset:2048 lds
    buffer_load_dwordx4 v9, s[12:15], s72 offen offset:3072 lds
    s_add_u32 m0, s82, 0
    s_lshl_b32 s72, s5, 7
    s_add_u32 s72, s72, s74
    buffer_load_dwordx4 v2, s[8:11], s72 offen offset:0 lds
    buffer_load_dwordx4 v3, s[8:11], s72 offen offset:1024 lds
    buffer_load_dwordx4 v4, s[8:11], s72 offen offset:2048 lds
    buffer_load_dwordx4 v5, s[8:11], s72 offen offset:3072 lds
    v_and_b32 v26, 3, v1
    v_lshlrev_b32 v26, 2, v26
    v_mov_b32 v27, 0
    v_add_u32 v26, 147456, v26
    ds_write_b32 v26, v27
    s_and_b32 s70, s2, 0x7c
    v_bfe_u32 v26, v1, 1, 2
    v_and_b32 v27, 1, v1
    v_lshl_add_u32 v26, v27, 7, v26
    v_add_u32 v26, s70, v26
    v_lshlrev_b32 v26, 2, v26
    s_mov_b32 s71, 15728640
    buffer_load_dword v44, v26, s[20:23], s71 offen sc1
    v_and_b32 v26, 3, v1
    s_and_b32 s70, s2, 0x9f
    v_lshlrev_b32 v26, 5, v26
    v_add_u32 v26, s70, v26
    v_lshlrev_b32 v26, 2, v26
    buffer_load_dword v43, v26, s[20:23], s71 offen sc1
    s_waitcnt lgkmcnt(0)
    s_lshl_b32 s73, s69, 2
    s_add_u32 s72, s65, s80
    s_and_b32 s72, s72, 3
    s_lshl_b32 s72, s72, 1
    s_lshr_b32 s72, 4, s72
    s_and_b32 s72, s72, 3
    s_add_u32 s73, s73, s72
    s_lshl_b32 s72, s73, 2
    s_add_u32 s72, s72, s62
    s_mul_i32 s88, s72, 36864
    s_mul_i32 s72, s80, 288
    s_add_u32 s88, s88, s72
    s_mov_b32 s92, s73
    s_lshl_b32 s70, s68, 4
    s_lshr_b32 s71, s73, 1
    s_add_u32 s70, s70, s71
    s_lshl_b32 s71, s68, 5
    s_add_u32 s71, s71, s73
    s_cmp_eq_u32 s63, 0
    s_cselect_b32 s84, s70, s71
    s_lshl_b32 s84, s84, 13
    s_waitcnt vmcnt(18)
    s_barrier
    s_bfe_u32 s5, s98, 262160
    s_add_u32 m0, s82, 53248
    s_lshl_b32 s72, s5, 19
    s_add_u32 s72, s72, s75
    buffer_load_dwordx4 v6, s[12:15], s72 offen offset:0 lds
    buffer_load_dwordx4 v7, s[12:15], s72 offen offset:1024 lds
    buffer_load_dwordx4 v8, s[12:15], s72 offen offset:2048 lds
    buffer_load_dwordx4 v9, s[12:15], s72 offen offset:3072 lds
    s_add_u32 m0, s82, 36864
    s_lshl_b32 s72, s5, 7
    s_add_u32 s72, s72, s74
    buffer_load_dwordx4 v2, s[8:11], s72 offen offset:0 lds
    buffer_load_dwordx4 v3, s[8:11], s72 offen offset:1024 lds
    buffer_load_dwordx4 v4, s[8:11], s72 offen offset:2048 lds
    buffer_load_dwordx4 v5, s[8:11], s72 offen offset:3072 lds
    s_movk_i32 s70, 3641
    v_add_u32 v26, 0, v1
    v_mul_u32_u24 v27, s70, v26
    v_lshrrev_b32 v27, 16, v27
    v_mul_u32_u24 v28, 18, v27
    v_sub_u32 v28, v26, v28
    v_and_b32 v29, 0x13, v27
    v_bfe_u32 v30, v27, 2, 1
    v_lshl_add_u32 v29, v30, 3, v29
    v_bfe_u32 v30, v27, 3, 1
    v_lshl_add_u32 v29, v30, 2, v29
    v_mul_u32_u24 v29, 1152, v29
    v_lshl_add_u32 v14, v28, 4, v29
    v_add_u32 v26, 64, v1
    v_mul_u32_u24 v27, s70, v26
    v_lshrrev_b32 v27, 16, v27
    v_mul_u32_u24 v28, 18, v27
    v_sub_u32 v28, v26, v28
    v_and_b32 v29, 0x13, v27
    v_bfe_u32 v30, v27, 2, 1
    v_lshl_add_u32 v29, v30, 3, v29
    v_bfe_u32 v30, v27, 3, 1
    v_lshl_add_u32 v29, v30, 2, v29
    v_mul_u32_u24 v29, 1152, v29
    v_lshl_add_u32 v15, v28, 4, v29
    v_subrev_u32 v15, 1024, v15
    v_add_u32 v26, 128, v1
    v_mul_u32_u24 v27, s70, v26
    v_lshrrev_b32 v27, 16, v27
    v_mul_u32_u24 v28, 18, v27
    v_sub_u32 v28, v26, v28
    v_and_b32 v29, 0x13, v27
    v_bfe_u32 v30, v27, 2, 1
    v_lshl_add_u32 v29, v30, 3, v29
    v_bfe_u32 v30, v27, 3, 1
    v_lshl_add_u32 v29, v30, 2, v29
    v_mul_u32_u24 v29, 1152, v29
    v_lshl_add_u32 v16, v28, 4, v29
    v_subrev_u32 v16, 2048, v16
    s_waitcnt vmcnt(10)
    s_barrier
    s_bfe_u32 s5, s98, 262164
    s_add_u32 m0, s82, 90112
    s_lshl_b32 s72, s5, 19
    s_add_u32 s72, s72, s75
    buffer_load_dwordx4 v6, s[12:15], s72 offen offset:0 lds
    buffer_load_dwordx4 v7, s[12:15], s72 offen offset:1024 lds
    buffer_load_dwordx4 v8, s[12:15], s72 offen offset:2048 lds
    buffer_load_dwordx4 v9, s[12:15], s72 offen offset:3072 lds
    s_add_u32 m0, s82, 73728
    s_lshl_b32 s72, s5, 7
    s_add_u32 s72, s72, s74
    buffer_load_dwordx4 v2, s[8:11], s72 offen offset:0 lds
    buffer_load_dwordx4 v3, s[8:11], s72 offen offset:1024 lds
    buffer_load_dwordx4 v4, s[8:11], s72 offen offset:2048 lds
    buffer_load_dwordx4 v5, s[8:11], s72 offen offset:3072 lds
    s_movk_i32 s70, 3641
    v_add_u32 v26, 192, v1
    v_mul_u32_u24 v27, s70, v26
    v_lshrrev_b32 v27, 16, v27
    v_mul_u32_u24 v28, 18, v27
    v_sub_u32 v28, v26, v28
    v_and_b32 v29, 0x13, v27
    v_bfe_u32 v30, v27, 2, 1
    v_lshl_add_u32 v29, v30, 3, v29
    v_bfe_u32 v30, v27, 3, 1
    v_lshl_add_u32 v29, v30, 2, v29
    v_mul_u32_u24 v29, 1152, v29
    v_lshl_add_u32 v17, v28, 4, v29
    v_subrev_u32 v17, 3072, v17
    v_add_u32 v26, 256, v1
    v_mul_u32_u24 v27, s70, v26
    v_lshrrev_b32 v27, 16, v27
    v_mul_u32_u24 v28, 18, v27
    v_sub_u32 v28, v26, v28
    v_and_b32 v29, 0x13, v27
    v_bfe_u32 v30, v27, 2, 1
    v_lshl_add_u32 v29, v30, 3, v29
    v_bfe_u32 v30, v27, 3, 1
    v_lshl_add_u32 v29, v30, 2, v29
    v_mul_u32_u24 v29, 1152, v29
    v_lshl_add_u32 v18, v28, 4, v29
    v_add_u32 v26, 320, v1
    v_mul_u32_u24 v27, s70, v26
    v_lshrrev_b32 v27, 16, v27
    v_mul_u32_u24 v28, 18, v27
    v_sub_u32 v28, v26, v28
    v_and_b32 v29, 0x13, v27
    v_bfe_u32 v30, v27, 2, 1
    v_lshl_add_u32 v29, v30, 3, v29
    v_bfe_u32 v30, v27, 3, 1
    v_lshl_add_u32 v29, v30, 2, v29
    v_mul_u32_u24 v29, 1152, v29
    v_lshl_add_u32 v19, v28, 4, v29
    v_subrev_u32 v19, 1024, v19
    s_waitcnt vmcnt(8)
    s_barrier
    s_bfe_u32 s5, s98, 262168
    s_add_u32 m0, s82, 126976
    s_lshl_b32 s72, s5, 19
    s_add_u32 s72, s72, s75
    buffer_load_dwordx4 v6, s[12:15], s72 offen offset:0 lds
    buffer_load_dwordx4 v7, s[12:15], s72 offen offset:1024 lds
    buffer_load_dwordx4 v8, s[12:15], s72 offen offset:2048 lds
    buffer_load_dwordx4 v9, s[12:15], s72 offen offset:3072 lds
    s_add_u32 m0, s82, 110592
    s_lshl_b32 s72, s5, 7
    s_add_u32 s72, s72, s74
    buffer_load_dwordx4 v2, s[8:11], s72 offen offset:0 lds
    buffer_load_dwordx4 v3, s[8:11], s72 offen offset:1024 lds
    buffer_load_dwordx4 v4, s[8:11], s72 offen offset:2048 lds
    buffer_load_dwordx4 v5, s[8:11], s72 offen offset:3072 lds
    s_bfe_u32 s5, s98, 262172
    s_add_u32 m0, s82, 16384
    s_lshl_b32 s72, s5, 19
    s_add_u32 s72, s72, s75
    buffer_load_dwordx4 v6, s[12:15], s72 offen offset:0 lds
    buffer_load_dwordx4 v7, s[12:15], s72 offen offset:1024 lds
    buffer_load_dwordx4 v8, s[12:15], s72 offen offset:2048 lds
    buffer_load_dwordx4 v9, s[12:15], s72 offen offset:3072 lds
    s_add_u32 m0, s82, 0
    s_lshl_b32 s72, s5, 7
    s_add_u32 s72, s72, s74
    buffer_load_dwordx4 v2, s[8:11], s72 offen offset:0 lds
    buffer_load_dwordx4 v3, s[8:11], s72 offen offset:1024 lds
    buffer_load_dwordx4 v4, s[8:11], s72 offen offset:2048 lds
    buffer_load_dwordx4 v5, s[8:11], s72 offen offset:3072 lds
    s_movk_i32 s70, 3641
    v_add_u32 v26, 384, v1
    v_mul_u32_u24 v27, s70, v26
    v_lshrrev_b32 v27, 16, v27
    v_mul_u32_u24 v28, 18, v27
    v_sub_u32 v28, v26, v28
    v_and_b32 v29, 0x13, v27
    v_bfe_u32 v30, v27, 2, 1
    v_lshl_add_u32 v29, v30, 3, v29
    v_bfe_u32 v30, v27, 3, 1
    v_lshl_add_u32 v29, v30, 2, v29
    v_mul_u32_u24 v29, 1152, v29
    v_lshl_add_u32 v20, v28, 4, v29
    v_subrev_u32 v20, 2048, v20
    v_add_u32 v26, 448, v1
    v_mul_u32_u24 v27, s70, v26
    v_lshrrev_b32 v27, 16, v27
    v_mul_u32_u24 v28, 18, v27
    v_sub_u32 v28, v26, v28
    v_and_b32 v29, 0x13, v27
    v_bfe_u32 v30, v27, 2, 1
    v_lshl_add_u32 v29, v30, 3, v29
    v_bfe_u32 v30, v27, 3, 1
    v_lshl_add_u32 v29, v30, 2, v29
    v_mul_u32_u24 v29, 1152, v29
    v_lshl_add_u32 v21, v28, 4, v29
    v_subrev_u32 v21, 3072, v21
    v_add_u32 v26, 512, v1
    v_mul_u32_u24 v27, s70, v26
    v_lshrrev_b32 v27, 16, v27
    v_mul_u32_u24 v28, 18, v27
    v_sub_u32 v28, v26, v28
    v_and_b32 v29, 0x13, v27
    v_bfe_u32 v30, v27, 2, 1
    v_lshl_add_u32 v29, v30, 3, v29
    v_bfe_u32 v30, v27, 3, 1
    v_lshl_add_u32 v29, v30, 2, v29
    v_mul_u32_u24 v29, 1152, v29
    v_lshl_add_u32 v22, v28, 4, v29
    s_waitcnt vmcnt(16)
    s_barrier
    s_bfe_u32 s5, s99, 262144
    s_add_u32 m0, s82, 53248
    s_lshl_b32 s72, s5, 19
    s_add_u32 s72, s72, s75
    buffer_load_dwordx4 v6, s[12:15], s72 offen offset:0 lds
    buffer_load_dwordx4 v7, s[12:15], s72 offen offset:1024 lds
    buffer_load_dwordx4 v8, s[12:15], s72 offen offset:2048 lds
    buffer_load_dwordx4 v9, s[12:15], s72 offen offset:3072 lds
    s_add_u32 m0, s82, 36864
    s_lshl_b32 s72, s5, 7
    s_add_u32 s72, s72, s74
    buffer_load_dwordx4 v2, s[8:11], s72 offen offset:0 lds
    buffer_load_dwordx4 v3, s[8:11], s72 offen offset:1024 lds
    buffer_load_dwordx4 v4, s[8:11], s72 offen offset:2048 lds
    buffer_load_dwordx4 v5, s[8:11], s72 offen offset:3072 lds
    s_mul_i32 s79, s62, 9216
    s_lshl_b32 s73, s69, 2
    s_add_u32 s72, s65, s80
    s_and_b32 s72, s72, 3
    s_lshl_b32 s72, s72, 1
    s_lshr_b32 s72, 97, s72
    s_and_b32 s72, s72, 3
    s_add_u32 s73, s73, s72
    s_lshl_b32 s72, s73, 2
    s_add_u32 s72, s72, s62
    s_mul_i32 s89, s72, 36864
    s_mul_i32 s72, s80, 288
    s_add_u32 s89, s89, s72
    s_mov_b32 s93, s73
    s_lshl_b32 s70, s68, 4
    s_lshr_b32 s71, s73, 1
    s_add_u32 s70, s70, s71
    s_lshl_b32 s71, s68, 5
    s_add_u32 s71, s71, s73
    s_cmp_eq_u32 s63, 0
    s_cselect_b32 s85, s70, s71
    s_lshl_b32 s85, s85, 13
    s_waitcnt vmcnt(16)
    s_barrier
    s_add_u32 m0, s83, 73728
    s_mov_b32 s72, s84
    buffer_load_dwordx4 v10, s[24:27], s72 offen offset:0 lds
    buffer_load_dwordx4 v11, s[24:27], s72 offen offset:1024 lds
    buffer_load_dwordx4 v12, s[24:27], s72 offen offset:2048 lds
    buffer_load_dwordx4 v13, s[24:27], s72 offen offset:3072 lds
    s_add_u32 m0, s83, 77824
    s_add_u32 s72, s84, 4096
    buffer_load_dwordx4 v10, s[24:27], s72 offen offset:0 lds
    buffer_load_dwordx4 v11, s[24:27], s72 offen offset:1024 lds
    buffer_load_dwordx4 v12, s[24:27], s72 offen offset:2048 lds
    buffer_load_dwordx4 v13, s[24:27], s72 offen offset:3072 lds
    s_lshl_b32 s73, s69, 2
    s_add_u32 s72, s65, s80
    s_and_b32 s72, s72, 3
    s_lshl_b32 s72, s72, 1
    s_lshr_b32 s72, 218, s72
    s_and_b32 s72, s72, 3
    s_add_u32 s73, s73, s72
    s_lshl_b32 s72, s73, 2
    s_add_u32 s72, s72, s62
    s_mul_i32 s90, s72, 36864
    s_mul_i32 s72, s80, 288
    s_add_u32 s90, s90, s72
    s_mov_b32 s94, s73
    s_lshl_b32 s70, s68, 4
    s_lshr_b32 s71, s73, 1
    s_add_u32 s70, s70, s71
    s_lshl_b32 s71, s68, 5
    s_add_u32 s71, s71, s73
    s_cmp_eq_u32 s63, 0
    s_cselect_b32 s86, s70, s71
    s_lshl_b32 s86, s86, 13
    s_lshl_b32 s73, s69, 2
    s_add_u32 s72, s65, s80
    s_and_b32 s72, s72, 3
    s_lshl_b32 s72, s72, 1
    s_lshr_b32 s72, 191, s72
    s_and_b32 s72, s72, 3
    s_add_u32 s73, s73, s72
    s_lshl_b32 s72, s73, 2
    s_add_u32 s72, s72, s62
    s_mul_i32 s91, s72, 36864
    s_mul_i32 s72, s80, 288
    s_add_u32 s91, s91, s72
    s_mov_b32 s95, s73
    s_lshl_b32 s70, s68, 4
    s_lshr_b32 s71, s73, 1
    s_add_u32 s70, s70, s71
    s_lshl_b32 s71, s68, 5
    s_add_u32 s71, s71, s73
    s_cmp_eq_u32 s63, 0
    s_cselect_b32 s87, s70, s71
    s_lshl_b32 s87, s87, 13
    s_waitcnt vmcnt(16)
    s_barrier
    s_add_u32 m0, s79, 110592
    s_nop 0
    buffer_load_dwordx4 v14, s[28:31], s88 offen offset:0 lds
    buffer_load_dwordx4 v15, s[28:31], s88 offen offset:1024 lds
    buffer_load_dwordx4 v16, s[28:31], s88 offen offset:2048 lds
    buffer_load_dwordx4 v17, s[28:31], s88 offen offset:3072 lds
    s_add_u32 m0, s79, 114688
    s_nop 0
    buffer_load_dwordx4 v18, s[28:31], s88 offen offset:0 lds
    buffer_load_dwordx4 v19, s[28:31], s88 offen offset:1024 lds
    buffer_load_dwordx4 v20, s[28:31], s88 offen offset:2048 lds
    buffer_load_dwordx4 v21, s[28:31], s88 offen offset:3072 lds
    s_add_u32 m0, s79, 118784
    s_nop 0
    buffer_load_dwordx4 v22, s[28:31], s88 offen offset:0 lds
    s_waitcnt vmcnt(17)
    s_barrier
    s_add_u32 m0, s83, 0
    s_mov_b32 s72, s85
    buffer_load_dwordx4 v10, s[24:27], s72 offen offset:0 lds
    buffer_load_dwordx4 v11, s[24:27], s72 offen offset:1024 lds
    buffer_load_dwordx4 v12, s[24:27], s72 offen offset:2048 lds
    buffer_load_dwordx4 v13, s[24:27], s72 offen offset:3072 lds
    s_add_u32 m0, s83, 4096
    s_add_u32 s72, s85, 4096
    buffer_load_dwordx4 v10, s[24:27], s72 offen offset:0 lds
    buffer_load_dwordx4 v11, s[24:27], s72 offen offset:1024 lds
    buffer_load_dwordx4 v12, s[24:27], s72 offen offset:2048 lds
    buffer_load_dwordx4 v13, s[24:27], s72 offen offset:3072 lds
    s_waitcnt vmcnt(8)
    s_barrier
    s_add_u32 m0, s79, 36864
    s_nop 0
    buffer_load_dwordx4 v14, s[28:31], s89 offen offset:0 lds
    buffer_load_dwordx4 v15, s[28:31], s89 offen offset:1024 lds
    buffer_load_dwordx4 v16, s[28:31], s89 offen offset:2048 lds
    buffer_load_dwordx4 v17, s[28:31], s89 offen offset:3072 lds
    s_add_u32 m0, s79, 40960
    s_nop 0
    buffer_load_dwordx4 v18, s[28:31], s89 offen offset:0 lds
    buffer_load_dwordx4 v19, s[28:31], s89 offen offset:1024 lds
    buffer_load_dwordx4 v20, s[28:31], s89 offen offset:2048 lds
    buffer_load_dwordx4 v21, s[28:31], s89 offen offset:3072 lds
    s_add_u32 m0, s79, 45056
    s_nop 0
    buffer_load_dwordx4 v22, s[28:31], s89 offen offset:0 lds
    s_add_u32 s72, s65, s80
    s_and_b32 s72, s72, 3
    s_lshl_b32 s72, s72, 2
    s_add_u32 s72, s72, s80
    s_lshl_b32 s72, s72, 1
    s_lshr_b32 s101, 3034112484, s72
    s_and_b32 s101, s101, 3
    s_mov_b32 s70, 1664525
    v_mul_lo_u32 v43, v43, s70
    v_add_u32 v43, 1013904223, v43
    v_lshlrev_b32 v42, 4, v1
    v_and_b32 v26, 3, v1
    v_lshlrev_b32 v26, 1, v26
    v_sub_u32 v26, 32, v26
    s_lshl_b32 s70, s63, 4
    s_add_u32 s70, s70, s68
    s_lshl_b32 s78, s70, 16
    s_and_b32 s70, s92, 3
    v_readlane_b32 s71, v43, s70
    s_lshl_b32 s92, s92, 11
    s_add_u32 s92, s92, s78
    v_alignbit_b32 v80, s71, s71, v26
    v_lshlrev_b32 v81, 1, v80
    s_and_b32 s70, s93, 3
    v_readlane_b32 s71, v43, s70
    s_lshl_b32 s93, s93, 11
    s_add_u32 s93, s93, s78
    v_alignbit_b32 v82, s71, s71, v26
    v_lshlrev_b32 v83, 1, v82
    s_and_b32 s70, s94, 3
    v_readlane_b32 s71, v43, s70
    s_lshl_b32 s94, s94, 11
    s_add_u32 s94, s94, s78
    v_alignbit_b32 v84, s71, s71, v26
    v_lshlrev_b32 v85, 1, v84
    s_and_b32 s70, s95, 3
    v_readlane_b32 s71, v43, s70
    s_lshl_b32 s95, s95, 11
    s_add_u32 s95, s95, s78
    v_alignbit_b32 v86, s71, s71, v26
    v_lshlrev_b32 v87, 1, v86
    s_mov_b32 s77, 0x07050301
    s_mov_b32 s36, 0x7fff7fff
    v_add_u32 v32, s83, v42
    v_add_u32 v32, 73728, v32
    s_barrier
    s_add_u32 m0, s83, 73728
    s_mov_b32 s72, s86
    buffer_load_dwordx4 v10, s[24:27], s72 offen offset:0 lds
    buffer_load_dwordx4 v11, s[24:27], s72 offen offset:1024 lds
    buffer_load_dwordx4 v12, s[24:27], s72 offen offset:2048 lds
    buffer_load_dwordx4 v13, s[24:27], s72 offen offset:3072 lds
    s_add_u32 m0, s83, 77824
    s_add_u32 s72, s86, 4096
    buffer_load_dwordx4 v10, s[24:27], s72 offen offset:0 lds
    buffer_load_dwordx4 v11, s[24:27], s72 offen offset:1024 lds
    buffer_load_dwordx4 v12, s[24:27], s72 offen offset:2048 lds
    buffer_load_dwordx4 v13, s[24:27], s72 offen offset:3072 lds
    s_waitcnt vmcnt(8)
    s_barrier
    s_add_u32 m0, s79, 110592
    s_nop 0
    buffer_load_dwordx4 v14, s[28:31], s90 offen offset:0 lds
    buffer_load_dwordx4 v15, s[28:31], s90 offen offset:1024 lds
    buffer_load_dwordx4 v16, s[28:31], s90 offen offset:2048 lds
    buffer_load_dwordx4 v17, s[28:31], s90 offen offset:3072 lds
    s_add_u32 m0, s79, 114688
    s_nop 0
    buffer_load_dwordx4 v18, s[28:31], s90 offen offset:0 lds
    buffer_load_dwordx4 v19, s[28:31], s90 offen offset:1024 lds
    buffer_load_dwordx4 v20, s[28:31], s90 offen offset:2048 lds
    buffer_load_dwordx4 v21, s[28:31], s90 offen offset:3072 lds
    s_add_u32 m0, s79, 118784
    s_nop 0
    buffer_load_dwordx4 v22, s[28:31], s90 offen offset:0 lds
    s_lshl_b32 s6, s63, 2
    s_add_u32 s6, s6, s65
    s_lshl_b32 s6, s6, 2
    s_add_u32 s6, s6, s80
    s_lshl_b32 s70, s6, 3
    s_add_u32 s70, s70, s69
    s_mul_i32 s45, s70, 36864
    s_add_u32 s45, s45, 2097152
    s_lshl_b32 s70, s62, 10
    s_add_u32 s45, s45, s70
    s_lshl_b32 s46, s65, 3
    s_add_u32 s46, s46, s69
    s_mul_i32 s46, s46, 36864
    s_mul_i32 s70, s63, 1152
    s_add_u32 s46, s46, s70
    s_mul_i32 s70, s80, 288
    s_add_u32 s46, s46, s70
    s_mov_b32 s47, 0x3f80
    s_mov_b32 s48, 0x3f800000
    s_mov_b32 s70, 1664525
    v_mul_lo_u32 v44, v44, s70
    v_add_u32 v44, 1013904223, v44
    v_and_b32 v26, 7, v1
    s_lshl_b32 s70, s6, 3
    s_add_u32 s71, s70, s69
    s_lshl_b32 s71, s71, 10
    s_add_u32 s71, s71, 14680064
    v_lshl_add_u32 v45, v26, 7, s71
    v_and_b32 v34, 15, v1
    v_mul_u32_u24 v34, 2304, v34
    v_bfe_u32 v29, v1, 4, 1
    v_lshl_add_u32 v34, v29, 5, v34
    v_bfe_u32 v29, v1, 5, 1
    v_lshl_add_u32 v34, v29, 4, v34
    s_lshl_b32 s70, s62, 6
    v_add_u32 v34, s70, v34
    s_barrier
    s_add_u32 m0, s83, 0
    s_mov_b32 s72, s87
    buffer_load_dwordx4 v10, s[24:27], s72 offen offset:0 lds
    buffer_load_dwordx4 v11, s[24:27], s72 offen offset:1024 lds
    buffer_load_dwordx4 v12, s[24:27], s72 offen offset:2048 lds
    buffer_load_dwordx4 v13, s[24:27], s72 offen offset:3072 lds
    s_add_u32 m0, s83, 4096
    s_add_u32 s72, s87, 4096
    buffer_load_dwordx4 v10, s[24:27], s72 offen offset:0 lds
    buffer_load_dwordx4 v11, s[24:27], s72 offen offset:1024 lds
    buffer_load_dwordx4 v12, s[24:27], s72 offen offset:2048 lds
    buffer_load_dwordx4 v13, s[24:27], s72 offen offset:3072 lds
    s_waitcnt vmcnt(8)
    s_barrier
    s_cmp_eq_u32 s101, 0
    s_cbranch_scc1 L_so0
    buffer_load_dwordx4 v[48:51], v42, s[20:23], s92 offen offset:0 sc1
    buffer_load_dwordx4 v[52:55], v42, s[20:23], s92 offen offset:1024 sc1
L_so0:
    s_cmp_eq_u32 s101, 1
    s_cbranch_scc1 L_so1
    buffer_load_dwordx4 v[56:59], v42, s[20:23], s93 offen offset:0 sc1
    buffer_load_dwordx4 v[60:63], v42, s[20:23], s93 offen offset:1024 sc1
L_so1:
    s_cmp_eq_u32 s101, 2
    s_cbranch_scc1 L_so2
    buffer_load_dwordx4 v[64:67], v42, s[20:23], s94 offen offset:0 sc1
    buffer_load_dwordx4 v[68:71], v42, s[20:23], s94 offen offset:1024 sc1
L_so2:
    s_cmp_eq_u32 s101, 3
    s_cbranch_scc1 L_so3
    buffer_load_dwordx4 v[72:75], v42, s[20:23], s95 offen offset:0 sc1
    buffer_load_dwordx4 v[76:79], v42, s[20:23], s95 offen offset:1024 sc1
L_so3:
    s_setprio 1
    s_add_u32 m0, s79, 36864
    s_nop 0
    buffer_load_dwordx4 v14, s[28:31], s91 offen offset:0 lds
    buffer_load_dwordx4 v15, s[28:31], s91 offen offset:1024 lds
    buffer_load_dwordx4 v16, s[28:31], s91 offen offset:2048 lds
    buffer_load_dwordx4 v17, s[28:31], s91 offen offset:3072 lds
    s_add_u32 m0, s79, 40960
    s_nop 0
    buffer_load_dwordx4 v18, s[28:31], s91 offen offset:0 lds
    buffer_load_dwordx4 v19, s[28:31], s91 offen offset:1024 lds
    buffer_load_dwordx4 v20, s[28:31], s91 offen offset:2048 lds
    buffer_load_dwordx4 v21, s[28:31], s91 offen offset:3072 lds
    s_add_u32 m0, s79, 45056
    s_nop 0
    buffer_load_dwordx4 v22, s[28:31], s91 offen offset:0 lds
    s_barrier
    s_waitcnt vmcnt(9)
    s_mov_b32 s4, 0
    s_branch L_pc_chk
L_pc_retry:
    s_sleep 4
    s_cmp_eq_u32 s101, 0
    s_cbranch_scc1 L_so4
    buffer_load_dwordx4 v[48:51], v42, s[20:23], s92 offen offset:0 sc1
    buffer_load_dwordx4 v[52:55], v42, s[20:23], s92 offen offset:1024 sc1
L_so4:
    s_cmp_eq_u32 s101, 1
    s_cbranch_scc1 L_so5
    buffer_load_dwordx4 v[56:59], v42, s[20:23], s93 offen offset:0 sc1
    buffer_load_dwordx4 v[60:63], v42, s[20:23], s93 offen offset:1024 sc1
L_so5:
    s_cmp_eq_u32 s101, 2
    s_cbranch_scc1 L_so6
    buffer_load_dwordx4 v[64:67], v42, s[20:23], s94 offen offset:0 sc1
    buffer_load_dwordx4 v[68:71], v42, s[20:23], s94 offen offset:1024 sc1
L_so6:
    s_cmp_eq_u32 s101, 3
    s_cbranch_scc1 L_so7
    buffer_load_dwordx4 v[72:75], v42, s[20:23], s95 offen offset:0 sc1
    buffer_load_dwordx4 v[76:79], v42, s[20:23], s95 offen offset:1024 sc1
L_so7:
    s_waitcnt vmcnt(0)
L_pc_chk:
    v_mov_b32 v26, 0
    s_cmp_eq_u32 s101, 0
    s_cbranch_scc1 L_so8
    v_perm_b32 v27, v49, v48, s77
    v_perm_b32 v28, v51, v50, s77
    v_xor_b32 v27, v27, v80
    v_xor_b32 v28, v28, v81
    v_or3_b32 v26, v26, v27, v28
    v_perm_b32 v27, v53, v52, s77
    v_perm_b32 v28, v55, v54, s77
    v_xor_b32 v27, v27, v80
    v_xor_b32 v28, v28, v81
    v_or3_b32 v26, v26, v27, v28
L_so8:
    s_cmp_eq_u32 s101, 1
    s_cbranch_scc1 L_so9
    v_perm_b32 v27, v57, v56, s77
    v_perm_b32 v28, v59, v58, s77
    v_xor_b32 v27, v27, v82
    v_xor_b32 v28, v28, v83
    v_or3_b32 v26, v26, v27, v28
    v_perm_b32 v27, v61, v60, s77
    v_perm_b32 v28, v63, v62, s77
    v_xor_b32 v27, v27, v82
    v_xor_b32 v28, v28, v83
    v_or3_b32 v26, v26, v27, v28
L_so9:
    s_cmp_eq_u32 s101, 2
    s_cbranch_scc1 L_so10
    v_perm_b32 v27, v65, v64, s77
    v_perm_b32 v28, v67, v66, s77
    v_xor_b32 v27, v27, v84
    v_xor_b32 v28, v28, v85
    v_or3_b32 v26, v26, v27, v28
    v_perm_b32 v27, v69, v68, s77
    v_perm_b32 v28, v71, v70, s77
    v_xor_b32 v27, v27, v84
    v_xor_b32 v28, v28, v85
    v_or3_b32 v26, v26, v27, v28
L_so10:
    s_cmp_eq_u32 s101, 3
    s_cbranch_scc1 L_so11
    v_perm_b32 v27, v73, v72, s77
    v_perm_b32 v28, v75, v74, s77
    v_xor_b32 v27, v27, v86
    v_xor_b32 v28, v28, v87
    v_or3_b32 v26, v26, v27, v28
    v_perm_b32 v27, v77, v76, s77
    v_perm_b32 v28, v79, v78, s77
    v_xor_b32 v27, v27, v86
    v_xor_b32 v28, v28, v87
    v_or3_b32 v26, v26, v27, v28
L_so11:
    v_and_b32 v26, 0x80808080, v26
    v_cmp_ne_u32 vcc, 0, v26
    s_add_u32 s4, s4, 1
    s_cmp_ge_u32 s4, 262144
    s_cbranch_scc1 L_pc_done
    s_nop 1
    s_cbranch_vccnz L_pc_retry
L_pc_done:
    s_cmp_eq_u32 s101, 0
    s_cbranch_scc1 L_so12
    v_and_b32 v48, s36, v48
    v_and_b32 v49, s36, v49
    v_and_b32 v50, s36, v50
    v_and_b32 v51, s36, v51
    ds_write_b128 v32, v[48:51] offset:0
    v_and_b32 v52, s36, v52
    v_and_b32 v53, s36, v53
    v_and_b32 v54, s36, v54
    v_and_b32 v55, s36, v55
    ds_write_b128 v32, v[52:55] offset:1024
L_so12:
    s_cmp_eq_u32 s101, 1
    s_cbranch_scc1 L_so13
    v_and_b32 v56, s36, v56
    v_and_b32 v57, s36, v57
    v_and_b32 v58, s36, v58
    v_and_b32 v59, s36, v59
    ds_write_b128 v32, v[56:59] offset:2048
    v_and_b32 v60, s36, v60
    v_and_b32 v61, s36, v61
    v_and_b32 v62, s36, v62
    v_and_b32 v63, s36, v63
    ds_write_b128 v32, v[60:63] offset:3072
L_so13:
    s_cmp_eq_u32 s101, 2
    s_cbranch_scc1 L_so14
    v_and_b32 v64, s36, v64
    v_and_b32 v65, s36, v65
    v_and_b32 v66, s36, v66
    v_and_b32 v67, s36, v67
    ds_write_b128 v32, v[64:67] offset:4096
    v_and_b32 v68, s36, v68
    v_and_b32 v69, s36, v69
    v_and_b32 v70, s36, v70
    v_and_b32 v71, s36, v71
    ds_write_b128 v32, v[68:71] offset:5120
L_so14:
    s_cmp_eq_u32 s101, 3
    s_cbranch_scc1 L_so15
    v_and_b32 v72, s36, v72
    v_and_b32 v73, s36, v73
    v_and_b32 v74, s36, v74
    v_and_b32 v75, s36, v75
    ds_write_b128 v32, v[72:75] offset:6144
    v_and_b32 v76, s36, v76
    v_and_b32 v77, s36, v77
    v_and_b32 v78, s36, v78
    v_and_b32 v79, s36, v79
    ds_write_b128 v32, v[76:79] offset:7168
L_so15:
    s_waitcnt lgkmcnt(0)
    s_waitcnt vmcnt(0)
    s_barrier
    v_mov_b32 v80, 0
    v_mov_b32 v81, 0
    v_mov_b32 v82, 0
    v_mov_b32 v83, 0
    v_mov_b32 v84, 0
    v_mov_b32 v85, 0
    v_mov_b32 v86, 0
    v_mov_b32 v87, 0
    v_mov_b32 v26, 147456
    s_add_u32 s70, s69, 1
    s_and_b32 s70, s70, 7
    s_mul_i32 s70, s70, 4608
    s_add_u32 s85, s70, s45
    s_add_u32 s70, s69, 2
    s_and_b32 s70, s70, 7
    s_mul_i32 s70, s70, 4608
    s_add_u32 s86, s70, s45
    s_add_u32 s70, s69, 3
    s_and_b32 s70, s70, 7
    s_mul_i32 s70, s70, 4608
    s_add_u32 s87, s70, s45
    s_add_u32 s70, s69, 4
    s_and_b32 s70, s70, 7
    s_mul_i32 s70, s70, 4608
    s_add_u32 s88, s70, s45
    s_add_u32 s70, s69, 5
    s_and_b32 s70, s70, 7
    s_mul_i32 s70, s70, 4608
    s_add_u32 s89, s70, s45
    s_add_u32 s70, s69, 6
    s_and_b32 s70, s70, 7
    s_mul_i32 s70, s70, 4608
    s_add_u32 s90, s70, s45
    s_add_u32 s70, s69, 7
    s_and_b32 s70, s70, 7
    s_mul_i32 s70, s70, 4608
    s_add_u32 s91, s70, s45
    s_lshl_b32 s70, s62, 10
    s_add_u32 s70, s70, 110592
    v_add_u32 v35, s70, v42
    s_cmp_lg_u32 s62, 0
    s_cbranch_scc1 L_lgo
    s_mov_b32 s4, 0
L_mb:
    s_sleep 1
    ds_read_b32 v27, v26 offset:0
    s_add_u32 s4, s4, 1
    s_waitcnt lgkmcnt(0)
    v_readfirstlane_b32 s70, v27
    s_cmp_ge_u32 s4, 4194304
    s_cbranch_scc1 L_mb_done
    s_cmp_lt_u32 s70, 4
    s_cbranch_scc1 L_mb
L_mb_done:
    s_mov_b32 s4, 0
L_rw_poll:
    s_sleep 4
    v_mov_b32 v33, 0
    s_mov_b64 exec, 0xff
    buffer_atomic_or v33, v45, s[20:23], 0 offen sc0 sc1
    s_waitcnt vmcnt(0)
L_rw_chk:
    v_cmp_ne_u32 vcc, v33, v44
    s_add_u32 s4, s4, 1
    s_cmp_ge_u32 s4, 262144
    s_cbranch_scc1 L_rw_done
    s_nop 1
    s_cbranch_vccnz L_rw_poll
L_rw_done:
    s_mov_b64 exec, -1
    v_mov_b32 v27, 1
    ds_write_b32 v26, v27 offset:4
    s_branch L_lred
L_lgo:
    s_mov_b32 s4, 0
L_go:
    s_sleep 1
    ds_read_b32 v27, v26 offset:4
    s_add_u32 s4, s4, 1
    s_waitcnt lgkmcnt(0)
    v_readfirstlane_b32 s70, v27
    s_cmp_ge_u32 s4, 4194304
    s_cbranch_scc1 L_go_done
    s_cmp_lt_u32 s70, 1
    s_cbranch_scc1 L_go
L_go_done:
L_lred:
    buffer_load_dwordx4 v[52:55], v42, s[20:23], s85 offen sc1
    buffer_load_dwordx4 v[56:59], v42, s[20:23], s86 offen sc1
    buffer_load_dwordx4 v[60:63], v42, s[20:23], s87 offen sc1
    buffer_load_dwordx4 v[64:67], v42, s[20:23], s88 offen sc1
    buffer_load_dwordx4 v[68:71], v42, s[20:23], s89 offen sc1
    buffer_load_dwordx4 v[72:75], v42, s[20:23], s90 offen sc1
    buffer_load_dwordx4 v[76:79], v42, s[20:23], s91 offen sc1
    ds_read_b128 v[48:51], v35
    s_waitcnt lgkmcnt(0)
    v_dot2c_f32_bf16 v80, s47, v48
    v_dot2c_f32_bf16 v81, s48, v48
    v_dot2c_f32_bf16 v82, s47, v49
    v_dot2c_f32_bf16 v83, s48, v49
    v_dot2c_f32_bf16 v84, s47, v50
    v_dot2c_f32_bf16 v85, s48, v50
    v_dot2c_f32_bf16 v86, s47, v51
    v_dot2c_f32_bf16 v87, s48, v51
    s_waitcnt vmcnt(6)
    v_dot2c_f32_bf16 v80, s47, v52
    v_dot2c_f32_bf16 v81, s48, v52
    v_dot2c_f32_bf16 v82, s47, v53
    v_dot2c_f32_bf16 v83, s48, v53
    v_dot2c_f32_bf16 v84, s47, v54
    v_dot2c_f32_bf16 v85, s48, v54
    v_dot2c_f32_bf16 v86, s47, v55
    v_dot2c_f32_bf16 v87, s48, v55
    s_waitcnt vmcnt(5)
    v_dot2c_f32_bf16 v80, s47, v56
    v_dot2c_f32_bf16 v81, s48, v56
    v_dot2c_f32_bf16 v82, s47, v57
    v_dot2c_f32_bf16 v83, s48, v57
    v_dot2c_f32_bf16 v84, s47, v58
    v_dot2c_f32_bf16 v85, s48, v58
    v_dot2c_f32_bf16 v86, s47, v59
    v_dot2c_f32_bf16 v87, s48, v59
    s_waitcnt vmcnt(4)
    v_dot2c_f32_bf16 v80, s47, v60
    v_dot2c_f32_bf16 v81, s48, v60
    v_dot2c_f32_bf16 v82, s47, v61
    v_dot2c_f32_bf16 v83, s48, v61
    v_dot2c_f32_bf16 v84, s47, v62
    v_dot2c_f32_bf16 v85, s48, v62
    v_dot2c_f32_bf16 v86, s47, v63
    v_dot2c_f32_bf16 v87, s48, v63
    s_waitcnt vmcnt(3)
    v_dot2c_f32_bf16 v80, s47, v64
    v_dot2c_f32_bf16 v81, s48, v64
    v_dot2c_f32_bf16 v82, s47, v65
    v_dot2c_f32_bf16 v83, s48, v65
    v_dot2c_f32_bf16 v84, s47, v66
    v_dot2c_f32_bf16 v85, s48, v66
    v_dot2c_f32_bf16 v86, s47, v67
    v_dot2c_f32_bf16 v87, s48, v67
    s_waitcnt vmcnt(2)
    v_dot2c_f32_bf16 v80, s47, v68
    v_dot2c_f32_bf16 v81, s48, v68
    v_dot2c_f32_bf16 v82, s47, v69
    v_dot2c_f32_bf16 v83, s48, v69
    v_dot2c_f32_bf16 v84, s47, v70
    v_dot2c_f32_bf16 v85, s48, v70
    v_dot2c_f32_bf16 v86, s47, v71
    v_dot2c_f32_bf16 v87, s48, v71
    s_waitcnt vmcnt(1)
    v_dot2c_f32_bf16 v80, s47, v72
    v_dot2c_f32_bf16 v81, s48, v72
    v_dot2c_f32_bf16 v82, s47, v73
    v_dot2c_f32_bf16 v83, s48, v73
    v_dot2c_f32_bf16 v84, s47, v74
    v_dot2c_f32_bf16 v85, s48, v74
    v_dot2c_f32_bf16 v86, s47, v75
    v_dot2c_f32_bf16 v87, s48, v75
    s_waitcnt vmcnt(0)
    v_dot2c_f32_bf16 v80, s47, v76
    v_dot2c_f32_bf16 v81, s48, v76
    v_dot2c_f32_bf16 v82, s47, v77
    v_dot2c_f32_bf16 v83, s48, v77
    v_dot2c_f32_bf16 v84, s47, v78
    v_dot2c_f32_bf16 v85, s48, v78
    v_dot2c_f32_bf16 v86, s47, v79
    v_dot2c_f32_bf16 v87, s48, v79
    s_nop 2
    v_cvt_pk_bf16_f32 v48, v80, v81
    v_cvt_pk_bf16_f32 v49, v82, v83
    v_cvt_pk_bf16_f32 v50, v84, v85
    v_cvt_pk_bf16_f32 v51, v86, v87
    s_nop 1
    v_permlane16_swap_b32 v48, v50
    v_permlane16_swap_b32 v49, v51
    s_nop 1
    buffer_store_dwordx4 v[48:51], v34, s[32:35], s46 offen
L_ldone:
    s_endpgm
.p2align 6
L_compute:
    s_waitcnt lgkmcnt(0)
    s_barrier
    ds_read_b128 a[16:19], v2 offset:0
    ds_read_b64_tr_b16 a[0:1], v10 offset:0
    ds_read_b64_tr_b16 a[2:3], v10 offset:1024
    ds_read_b64_tr_b16 a[4:5], v11 offset:0
    ds_read_b64_tr_b16 a[6:7], v11 offset:1024
    ds_read_b64_tr_b16 a[8:9], v12 offset:0
    ds_read_b64_tr_b16 a[10:11], v12 offset:1024
    ds_read_b64_tr_b16 a[12:13], v13 offset:0
    ds_read_b64_tr_b16 a[14:15], v13 offset:1024
    s_waitcnt lgkmcnt(6)
    v_mfma_f32_32x32x16_bf16 v[48:63], a[0:3], a[16:19], 0
    ds_read_b128 a[20:23], v3 offset:0
    ds_read_b64_tr_b16 a[0:1], v10 offset:4096
    ds_read_b64_tr_b16 a[2:3], v10 offset:5120
    v_add_u32 v6, 73728, v2
    v_add_u32 v7, 73728, v3
    v_add_u32 v8, 73728, v4
    s_waitcnt lgkmcnt(7)
    v_mfma_f32_32x32x16_bf16 v[64:79], a[4:7], a[16:19], 0
    ds_read_b64_tr_b16 a[4:5], v11 offset:4096
    ds_read_b64_tr_b16 a[6:7], v11 offset:5120
    v_add_u32 v9, 73728, v5
    v_add_u32 v14, 73728, v10
    v_add_u32 v15, 73728, v11
    s_waitcnt lgkmcnt(7)
    v_mfma_f32_32x32x16_bf16 v[80:95], a[8:11], a[16:19], 0
    ds_read_b64_tr_b16 a[8:9], v12 offset:4096
    ds_read_b64_tr_b16 a[10:11], v12 offset:5120
    v_add_u32 v16, 73728, v12
    v_add_u32 v17, 73728, v13
    s_mov_b32 s20, s60
    s_waitcnt lgkmcnt(7)
    v_mfma_f32_32x32x16_bf16 v[96:111], a[12:15], a[16:19], 0
    ds_read_b64_tr_b16 a[12:13], v13 offset:4096
    ds_read_b64_tr_b16 a[14:15], v13 offset:5120
    s_and_b32 s21, s61, 0xffff
    s_mov_b32 s22, 17825792
    s_mov_b32 s23, 0x20000
    s_waitcnt lgkmcnt(6)
    v_mfma_f32_32x32x16_bf16 v[48:63], a[0:3], a[20:23], v[48:63]
    ds_read_b128 a[16:19], v4 offset:0
    ds_read_b64_tr_b16 a[0:1], v10 offset:8192
    ds_read_b64_tr_b16 a[2:3], v10 offset:9216
    s_mov_b32 s32, s56
    s_and_b32 s33, s57, 0xffff
    s_mov_b32 s34, 1179648
    s_waitcnt lgkmcnt(7)
    v_mfma_f32_32x32x16_bf16 v[64:79], a[4:7], a[20:23], v[64:79]
    ds_read_b64_tr_b16 a[4:5], v11 offset:8192
    ds_read_b64_tr_b16 a[6:7], v11 offset:9216
    s_mov_b32 s35, 0x20000
    v_and_b32 v26, 31, v1
    v_and_b32 v28, 15, v1
    s_waitcnt lgkmcnt(7)
    v_mfma_f32_32x32x16_bf16 v[80:95], a[8:11], a[20:23], v[80:95]
    ds_read_b64_tr_b16 a[8:9], v12 offset:8192
    ds_read_b64_tr_b16 a[10:11], v12 offset:9216
    v_xor_b32 v28, v28, v27
    v_lshlrev_b32 v28, 4, v28
    v_lshl_add_u32 v28, v26, 8, v28
    s_waitcnt lgkmcnt(7)
    v_mfma_f32_32x32x16_bf16 v[96:111], a[12:15], a[20:23], v[96:111]
    ds_read_b64_tr_b16 a[12:13], v13 offset:8192
    ds_read_b64_tr_b16 a[14:15], v13 offset:9216
    v_add_u32 v35, s83, v28
    v_add_u32 v35, 110592, v35
    s_and_b32 s70, s2, 0x7c
    s_waitcnt lgkmcnt(6)
    v_mfma_f32_32x32x16_bf16 v[48:63], a[0:3], a[16:19], v[48:63]
    ds_read_b128 a[20:23], v5 offset:0
    ds_read_b64_tr_b16 a[0:1], v10 offset:12288
    ds_read_b64_tr_b16 a[2:3], v10 offset:13312
    v_bfe_u32 v29, v1, 1, 2
    v_and_b32 v30, 1, v1
    v_lshl_add_u32 v29, v30, 7, v29
    s_waitcnt lgkmcnt(7)
    v_mfma_f32_32x32x16_bf16 v[64:79], a[4:7], a[16:19], v[64:79]
    ds_read_b64_tr_b16 a[4:5], v11 offset:12288
    ds_read_b64_tr_b16 a[6:7], v11 offset:13312
    v_add_u32 v29, s70, v29
    v_lshlrev_b32 v29, 2, v29
    s_mov_b32 s71, 15728640
    s_waitcnt lgkmcnt(7)
    v_mfma_f32_32x32x16_bf16 v[80:95], a[8:11], a[16:19], v[80:95]
    ds_read_b64_tr_b16 a[8:9], v12 offset:12288
    ds_read_b64_tr_b16 a[10:11], v12 offset:13312
    buffer_load_dword v44, v29, s[20:23], s71 offen sc1
    s_lshl_b32 s6, s63, 2
    s_add_u32 s6, s6, s65
    s_waitcnt lgkmcnt(7)
    v_mfma_f32_32x32x16_bf16 v[96:111], a[12:15], a[16:19], v[96:111]
    ds_read_b64_tr_b16 a[12:13], v13 offset:12288
    ds_read_b64_tr_b16 a[14:15], v13 offset:13312
    s_lshl_b32 s6, s6, 2
    s_add_u32 s6, s6, s80
    v_lshrrev_b32 v26, 4, v1
    s_waitcnt lgkmcnt(6)
    v_mfma_f32_32x32x16_bf16 v[48:63], a[0:3], a[20:23], v[48:63]
    s_waitcnt lgkmcnt(4)
    v_mfma_f32_32x32x16_bf16 v[64:79], a[4:7], a[20:23], v[64:79]
    s_waitcnt lgkmcnt(0)
    s_barrier
    ds_read_b128 a[16:19], v2 offset:36864
    ds_read_b64_tr_b16 a[0:1], v10 offset:36864
    ds_read_b64_tr_b16 a[2:3], v10 offset:37888
    ds_read_b64_tr_b16 a[4:5], v11 offset:36864
    ds_read_b64_tr_b16 a[6:7], v11 offset:37888
    v_mfma_f32_32x32x16_bf16 v[80:95], a[8:11], a[20:23], v[80:95]
    ds_read_b64_tr_b16 a[8:9], v12 offset:36864
    ds_read_b64_tr_b16 a[10:11], v12 offset:37888
    v_mfma_f32_32x32x16_bf16 v[96:111], a[12:15], a[20:23], v[96:111]
    ds_read_b64_tr_b16 a[12:13], v13 offset:36864
    ds_read_b64_tr_b16 a[14:15], v13 offset:37888
    s_waitcnt lgkmcnt(6)
    v_mfma_f32_32x32x16_bf16 v[48:63], a[0:3], a[16:19], v[48:63]
    ds_read_b128 a[20:23], v3 offset:36864
    ds_read_b64_tr_b16 a[0:1], v10 offset:40960
    ds_read_b64_tr_b16 a[2:3], v10 offset:41984
    v_and_b32 v29, 15, v1
    v_xor_b32 v28, v26, v29
    s_waitcnt lgkmcnt(7)
    v_mfma_f32_32x32x16_bf16 v[64:79], a[4:7], a[16:19], v[64:79]
    ds_read_b64_tr_b16 a[4:5], v11 offset:40960
    ds_read_b64_tr_b16 a[6:7], v11 offset:41984
    v_lshlrev_b32 v28, 4, v28
    v_lshl_add_u32 v28, v29, 8, v28
    s_waitcnt lgkmcnt(7)
    v_mfma_f32_32x32x16_bf16 v[80:95], a[8:11], a[16:19], v[80:95]
    ds_read_b64_tr_b16 a[8:9], v12 offset:40960
    ds_read_b64_tr_b16 a[10:11], v12 offset:41984
    v_add_u32 v28, 73728, v28
    v_add_u32 v36, s83, v28
    s_waitcnt lgkmcnt(7)
    v_mfma_f32_32x32x16_bf16 v[96:111], a[12:15], a[16:19], v[96:111]
    ds_read_b64_tr_b16 a[12:13], v13 offset:40960
    ds_read_b64_tr_b16 a[14:15], v13 offset:41984
    v_xor_b32 v37, 64, v36
    v_xor_b32 v38, 128, v36
    s_waitcnt lgkmcnt(6)
    v_mfma_f32_32x32x16_bf16 v[48:63], a[0:3], a[20:23], v[48:63]
    ds_read_b128 a[16:19], v4 offset:36864
    ds_read_b64_tr_b16 a[0:1], v10 offset:45056
    ds_read_b64_tr_b16 a[2:3], v10 offset:46080
    v_xor_b32 v39, 192, v36
    v_lshlrev_b32 v42, 4, v1
    s_waitcnt lgkmcnt(7)
    v_mfma_f32_32x32x16_bf16 v[64:79], a[4:7], a[20:23], v[64:79]
    ds_read_b64_tr_b16 a[4:5], v11 offset:45056
    ds_read_b64_tr_b16 a[6:7], v11 offset:46080
    v_lshlrev_b32 v26, 4, v27
    v_bfe_u32 v28, v1, 4, 1
    s_waitcnt lgkmcnt(7)
    v_mfma_f32_32x32x16_bf16 v[80:95], a[8:11], a[20:23], v[80:95]
    ds_read_b64_tr_b16 a[8:9], v12 offset:45056
    ds_read_b64_tr_b16 a[10:11], v12 offset:46080
    v_lshl_add_u32 v26, v28, 2, v26
    v_bfe_u32 v30, v1, 2, 2
    s_waitcnt lgkmcnt(7)
    v_mfma_f32_32x32x16_bf16 v[96:111], a[12:15], a[20:23], v[96:111]
    ds_read_b64_tr_b16 a[12:13], v13 offset:45056
    ds_read_b64_tr_b16 a[14:15], v13 offset:46080
    v_add_u32 v26, v26, v30
    v_mul_u32_u24 v26, 288, v26
    s_waitcnt lgkmcnt(6)
    v_mfma_f32_32x32x16_bf16 v[48:63], a[0:3], a[16:19], v[48:63]
    ds_read_b128 a[20:23], v5 offset:36864
    ds_read_b64_tr_b16 a[0:1], v10 offset:49152
    ds_read_b64_tr_b16 a[2:3], v10 offset:50176
    v_and_b32 v30, 3, v1
    v_lshl_add_u32 v26, v30, 3, v26
    s_waitcnt lgkmcnt(7)
    v_mfma_f32_32x32x16_bf16 v[64:79], a[4:7], a[16:19], v[64:79]
    ds_read_b64_tr_b16 a[4:5], v11 offset:49152
    ds_read_b64_tr_b16 a[6:7], v11 offset:50176
    v_add_u32 v40, 110592, v26
    v_add_u32 v41, 36864, v26
    s_waitcnt lgkmcnt(7)
    v_mfma_f32_32x32x16_bf16 v[80:95], a[8:11], a[16:19], v[80:95]
    ds_read_b64_tr_b16 a[8:9], v12 offset:49152
    ds_read_b64_tr_b16 a[10:11], v12 offset:50176
    v_lshlrev_b32 v28, 10, v28
    v_lshl_add_u32 v28, v27, 8, v28
    s_waitcnt lgkmcnt(7)
    v_mfma_f32_32x32x16_bf16 v[96:111], a[12:15], a[16:19], v[96:111]
    ds_read_b64_tr_b16 a[12:13], v13 offset:49152
    ds_read_b64_tr_b16 a[14:15], v13 offset:50176
    v_lshl_add_u32 v34, v29, 4, v28
    v_mul_u32_u24 v32, 2304, v29
    s_waitcnt lgkmcnt(6)
    v_mfma_f32_32x32x16_bf16 v[48:63], a[0:3], a[20:23], v[48:63]
    s_waitcnt lgkmcnt(4)
    v_mfma_f32_32x32x16_bf16 v[64:79], a[4:7], a[20:23], v[64:79]
    s_waitcnt lgkmcnt(0)
    s_barrier
    ds_read_b128 a[16:19], v6 offset:0
    ds_read_b64_tr_b16 a[0:1], v14 offset:0
    ds_read_b64_tr_b16 a[2:3], v14 offset:1024
    ds_read_b64_tr_b16 a[4:5], v15 offset:0
    ds_read_b64_tr_b16 a[6:7], v15 offset:1024
    v_mfma_f32_32x32x16_bf16 v[80:95], a[8:11], a[20:23], v[80:95]
    ds_read_b64_tr_b16 a[8:9], v16 offset:0
    ds_read_b64_tr_b16 a[10:11], v16 offset:1024
    v_mfma_f32_32x32x16_bf16 v[96:111], a[12:15], a[20:23], v[96:111]
    ds_read_b64_tr_b16 a[12:13], v17 offset:0
    ds_read_b64_tr_b16 a[14:15], v17 offset:1024
    s_waitcnt lgkmcnt(6)
    v_mfma_f32_32x32x16_bf16 v[48:63], a[0:3], a[16:19], v[48:63]
    ds_read_b128 a[20:23], v7 offset:0
    ds_read_b64_tr_b16 a[0:1], v14 offset:4096
    ds_read_b64_tr_b16 a[2:3], v14 offset:5120
    v_lshrrev_b32 v28, 4, v1
    v_lshlrev_b32 v28, 3, v28
    s_waitcnt lgkmcnt(7)
    v_mfma_f32_32x32x16_bf16 v[64:79], a[4:7], a[16:19], v[64:79]
    ds_read_b64_tr_b16 a[4:5], v15 offset:4096
    ds_read_b64_tr_b16 a[6:7], v15 offset:5120
    v_add_u32 v28, 256, v28
    v_add_u32 v32, v32, v28
    s_waitcnt lgkmcnt(7)
    v_mfma_f32_32x32x16_bf16 v[80:95], a[8:11], a[16:19], v[80:95]
    ds_read_b64_tr_b16 a[8:9], v16 offset:4096
    ds_read_b64_tr_b16 a[10:11], v16 offset:5120
    s_lshl_b32 s70, s63, 4
    s_add_u32 s70, s70, s68
    s_waitcnt lgkmcnt(7)
    v_mfma_f32_32x32x16_bf16 v[96:111], a[12:15], a[16:19], v[96:111]
    ds_read_b64_tr_b16 a[12:13], v17 offset:4096
    ds_read_b64_tr_b16 a[14:15], v17 offset:5120
    s_lshl_b32 s78, s70, 16
    s_lshl_b32 s70, s67, 11
    s_waitcnt lgkmcnt(6)
    v_mfma_f32_32x32x16_bf16 v[48:63], a[0:3], a[20:23], v[48:63]
    ds_read_b128 a[16:19], v8 offset:0
    ds_read_b64_tr_b16 a[0:1], v14 offset:8192
    ds_read_b64_tr_b16 a[2:3], v14 offset:9216
    s_add_u32 s78, s78, s70
    s_mov_b32 s77, 0x3e0293ee
    s_waitcnt lgkmcnt(7)
    v_mfma_f32_32x32x16_bf16 v[64:79], a[4:7], a[20:23], v[64:79]
    ds_read_b64_tr_b16 a[4:5], v15 offset:8192
    ds_read_b64_tr_b16 a[6:7], v15 offset:9216
    s_mov_b32 s36, 0x7fff7fff
    s_mov_b32 s52, 0x3e0293ee
    s_waitcnt lgkmcnt(7)
    v_mfma_f32_32x32x16_bf16 v[80:95], a[8:11], a[20:23], v[80:95]
    ds_read_b64_tr_b16 a[8:9], v16 offset:8192
    ds_read_b64_tr_b16 a[10:11], v16 offset:9216
    s_mov_b32 s53, 0x3e0293ee
    s_lshl_b32 s70, s6, 2
    s_waitcnt lgkmcnt(7)
    v_mfma_f32_32x32x16_bf16 v[96:111], a[12:15], a[20:23], v[96:111]
    ds_read_b64_tr_b16 a[12:13], v17 offset:8192
    ds_read_b64_tr_b16 a[14:15], v17 offset:9216
    s_add_u32 s70, s70, s62
    s_lshl_b32 s70, s70, 4
    s_waitcnt lgkmcnt(6)
    v_mfma_f32_32x32x16_bf16 v[48:63], a[0:3], a[16:19], v[48:63]
    ds_read_b128 a[20:23], v9 offset:0
    ds_read_b64_tr_b16 a[0:1], v14 offset:12288
    ds_read_b64_tr_b16 a[2:3], v14 offset:13312
    s_add_u32 s70, s70, s69
    s_mul_i32 s49, s70, 4608
    s_waitcnt lgkmcnt(7)
    v_mfma_f32_32x32x16_bf16 v[64:79], a[4:7], a[16:19], v[64:79]
    ds_read_b64_tr_b16 a[4:5], v15 offset:12288
    ds_read_b64_tr_b16 a[6:7], v15 offset:13312
    s_add_u32 s49, s49, 2097152
    s_add_u32 s50, s49, 36864
    s_waitcnt lgkmcnt(7)
    v_mfma_f32_32x32x16_bf16 v[80:95], a[8:11], a[16:19], v[80:95]
    ds_read_b64_tr_b16 a[8:9], v16 offset:12288
    ds_read_b64_tr_b16 a[10:11], v16 offset:13312
    s_lshl_b32 s70, s6, 3
    s_add_u32 s70, s70, s69
    s_waitcnt lgkmcnt(7)
    v_mfma_f32_32x32x16_bf16 v[96:111], a[12:15], a[16:19], v[96:111]
    ds_read_b64_tr_b16 a[12:13], v17 offset:12288
    ds_read_b64_tr_b16 a[14:15], v17 offset:13312
    s_mul_i32 s45, s70, 36864
    s_add_u32 s45, s45, 2097152
    s_waitcnt lgkmcnt(6)
    v_mfma_f32_32x32x16_bf16 v[48:63], a[0:3], a[20:23], v[48:63]
    s_waitcnt lgkmcnt(4)
    v_mfma_f32_32x32x16_bf16 v[64:79], a[4:7], a[20:23], v[64:79]
    s_waitcnt lgkmcnt(0)
    s_barrier
    ds_read_b128 a[16:19], v2 offset:0
    ds_read_b64_tr_b16 a[0:1], v10 offset:0
    ds_read_b64_tr_b16 a[2:3], v10 offset:1024
    ds_read_b64_tr_b16 a[4:5], v11 offset:0
    ds_read_b64_tr_b16 a[6:7], v11 offset:1024
    v_mfma_f32_32x32x16_bf16 v[80:95], a[8:11], a[20:23], v[80:95]
    ds_read_b64_tr_b16 a[8:9], v12 offset:0
    ds_read_b64_tr_b16 a[10:11], v12 offset:1024
    v_mfma_f32_32x32x16_bf16 v[96:111], a[12:15], a[20:23], v[96:111]
    ds_read_b64_tr_b16 a[12:13], v13 offset:0
    ds_read_b64_tr_b16 a[14:15], v13 offset:1024
    s_waitcnt lgkmcnt(6)
    v_mfma_f32_32x32x16_bf16 v[48:63], a[0:3], a[16:19], v[48:63]
    ds_read_b128 a[20:23], v3 offset:0
    ds_read_b64_tr_b16 a[0:1], v10 offset:4096
    ds_read_b64_tr_b16 a[2:3], v10 offset:5120
    v_xor_b32 v31, 0, v35
    ds_read_b128 a[32:35], v31 offset:0
    s_waitcnt lgkmcnt(8)
    v_mfma_f32_32x32x16_bf16 v[64:79], a[4:7], a[16:19], v[64:79]
    ds_read_b64_tr_b16 a[4:5], v11 offset:4096
    ds_read_b64_tr_b16 a[6:7], v11 offset:5120
    v_xor_b32 v31, 32, v35
    ds_read_b128 a[36:39], v31 offset:0
    s_waitcnt lgkmcnt(9)
    v_mfma_f32_32x32x16_bf16 v[80:95], a[8:11], a[16:19], v[80:95]
    ds_read_b64_tr_b16 a[8:9], v12 offset:4096
    ds_read_b64_tr_b16 a[10:11], v12 offset:5120
    v_xor_b32 v31, 64, v35
    ds_read_b128 a[40:43], v31 offset:0
    s_waitcnt lgkmcnt(10)
    v_mfma_f32_32x32x16_bf16 v[96:111], a[12:15], a[16:19], v[96:111]
    ds_read_b64_tr_b16 a[12:13], v13 offset:4096
    ds_read_b64_tr_b16 a[14:15], v13 offset:5120
    v_xor_b32 v31, 96, v35
    ds_read_b128 a[44:47], v31 offset:0
    s_waitcnt lgkmcnt(10)
    v_mfma_f32_32x32x16_bf16 v[48:63], a[0:3], a[20:23], v[48:63]
    ds_read_b128 a[16:19], v4 offset:0
    ds_read_b64_tr_b16 a[0:1], v10 offset:8192
    ds_read_b64_tr_b16 a[2:3], v10 offset:9216
    v_xor_b32 v31, 128, v35
    ds_read_b128 a[48:51], v31 offset:0
    s_waitcnt lgkmcnt(11)
    v_mfma_f32_32x32x16_bf16 v[64:79], a[4:7], a[20:23], v[64:79]
    ds_read_b64_tr_b16 a[4:5], v11 offset:8192
    ds_read_b64_tr_b16 a[6:7], v11 offset:9216
    v_xor_b32 v31, 160, v35
    ds_read_b128 a[52:55], v31 offset:0
    s_waitcnt lgkmcnt(11)
    v_mfma_f32_32x32x16_bf16 v[80:95], a[8:11], a[20:23], v[80:95]
    ds_read_b64_tr_b16 a[8:9], v12 offset:8192
    ds_read_b64_tr_b16 a[10:11], v12 offset:9216
    v_xor_b32 v31, 192, v35
    ds_read_b128 a[56:59], v31 offset:0
    s_waitcnt lgkmcnt(11)
    v_mfma_f32_32x32x16_bf16 v[96:111], a[12:15], a[20:23], v[96:111]
    ds_read_b64_tr_b16 a[12:13], v13 offset:8192
    ds_read_b64_tr_b16 a[14:15], v13 offset:9216
    v_xor_b32 v31, 224, v35
    ds_read_b128 a[60:63], v31 offset:0
    s_waitcnt lgkmcnt(10)
    v_mfma_f32_32x32x16_bf16 v[48:63], a[0:3], a[16:19], v[48:63]
    ds_read_b128 a[20:23], v5 offset:0
    ds_read_b64_tr_b16 a[0:1], v10 offset:12288
    ds_read_b64_tr_b16 a[2:3], v10 offset:13312
    s_lshl_b32 s70, s62, 10
    s_add_u32 s45, s45, s70
    s_waitcnt lgkmcnt(10)
    v_mfma_f32_32x32x16_bf16 v[64:79], a[4:7], a[16:19], v[64:79]
    ds_read_b64_tr_b16 a[4:5], v11 offset:12288
    ds_read_b64_tr_b16 a[6:7], v11 offset:13312
    s_lshl_b32 s46, s65, 3
    s_add_u32 s46, s46, s69
    s_waitcnt lgkmcnt(9)
    v_mfma_f32_32x32x16_bf16 v[80:95], a[8:11], a[16:19], v[80:95]
    ds_read_b64_tr_b16 a[8:9], v12 offset:12288
    ds_read_b64_tr_b16 a[10:11], v12 offset:13312
    s_mul_i32 s46, s46, 36864
    s_mul_i32 s70, s63, 1152
    s_waitcnt lgkmcnt(8)
    v_mfma_f32_32x32x16_bf16 v[96:111], a[12:15], a[16:19], v[96:111]
    ds_read_b64_tr_b16 a[12:13], v13 offset:12288
    ds_read_b64_tr_b16 a[14:15], v13 offset:13312
    s_add_u32 s46, s46, s70
    s_mul_i32 s70, s80, 288
    s_waitcnt lgkmcnt(6)
    v_mfma_f32_32x32x16_bf16 v[48:63], a[0:3], a[20:23], v[48:63]
    s_waitcnt lgkmcnt(4)
    v_mfma_f32_32x32x16_bf16 v[64:79], a[4:7], a[20:23], v[64:79]
    s_waitcnt lgkmcnt(0)
    s_barrier
    ds_read_b128 a[16:19], v2 offset:36864
    ds_read_b64_tr_b16 a[0:1], v10 offset:36864
    ds_read_b64_tr_b16 a[2:3], v10 offset:37888
    ds_read_b64_tr_b16 a[4:5], v11 offset:36864
    ds_read_b64_tr_b16 a[6:7], v11 offset:37888
    v_mfma_f32_32x32x16_bf16 v[80:95], a[8:11], a[20:23], v[80:95]
    ds_read_b64_tr_b16 a[8:9], v12 offset:36864
    ds_read_b64_tr_b16 a[10:11], v12 offset:37888
    v_mfma_f32_32x32x16_bf16 v[96:111], a[12:15], a[20:23], v[96:111]
    ds_read_b64_tr_b16 a[12:13], v13 offset:36864
    ds_read_b64_tr_b16 a[14:15], v13 offset:37888
    s_waitcnt lgkmcnt(6)
    v_mfma_f32_32x32x16_bf16 v[48:63], a[0:3], a[16:19], v[48:63]
    ds_read_b128 a[20:23], v3 offset:36864
    ds_read_b64_tr_b16 a[0:1], v10 offset:40960
    ds_read_b64_tr_b16 a[2:3], v10 offset:41984
    s_add_u32 s46, s46, s70
    s_mov_b32 s47, 0x3f80
    s_waitcnt lgkmcnt(7)
    v_mfma_f32_32x32x16_bf16 v[64:79], a[4:7], a[16:19], v[64:79]
    ds_read_b64_tr_b16 a[4:5], v11 offset:40960
    ds_read_b64_tr_b16 a[6:7], v11 offset:41984
    s_mov_b32 s48, 0x3f800000
    s_lshl_b32 s70, s62, 10
    s_waitcnt lgkmcnt(7)
    v_mfma_f32_32x32x16_bf16 v[80:95], a[8:11], a[16:19], v[80:95]
    ds_read_b64_tr_b16 a[8:9], v12 offset:40960
    ds_read_b64_tr_b16 a[10:11], v12 offset:41984
    s_sub_u32 s45, s45, s70
    s_waitcnt lgkmcnt(7)
    v_mfma_f32_32x32x16_bf16 v[96:111], a[12:15], a[16:19], v[96:111]
    ds_read_b64_tr_b16 a[12:13], v13 offset:40960
    ds_read_b64_tr_b16 a[14:15], v13 offset:41984
    s_waitcnt lgkmcnt(6)
    v_mfma_f32_32x32x16_bf16 v[48:63], a[0:3], a[20:23], v[48:63]
    ds_read_b128 a[16:19], v4 offset:36864
    ds_read_b64_tr_b16 a[0:1], v10 offset:45056
    ds_read_b64_tr_b16 a[2:3], v10 offset:46080
    s_waitcnt lgkmcnt(7)
    v_mfma_f32_32x32x16_bf16 v[64:79], a[4:7], a[20:23], v[64:79]
    ds_read_b64_tr_b16 a[4:5], v11 offset:45056
    ds_read_b64_tr_b16 a[6:7], v11 offset:46080
    s_waitcnt lgkmcnt(7)
    v_mfma_f32_32x32x16_bf16 v[80:95], a[8:11], a[20:23], v[80:95]
    ds_read_b64_tr_b16 a[8:9], v12 offset:45056
    ds_read_b64_tr_b16 a[10:11], v12 offset:46080
    s_waitcnt lgkmcnt(7)
    v_mfma_f32_32x32x16_bf16 v[96:111], a[12:15], a[20:23], v[96:111]
    ds_read_b64_tr_b16 a[12:13], v13 offset:45056
    ds_read_b64_tr_b16 a[14:15], v13 offset:46080
    s_waitcnt lgkmcnt(6)
    v_mfma_f32_32x32x16_bf16 v[48:63], a[0:3], a[16:19], v[48:63]
    ds_read_b128 a[20:23], v5 offset:36864
    ds_read_b64_tr_b16 a[0:1], v10 offset:49152
    ds_read_b64_tr_b16 a[2:3], v10 offset:50176
    s_waitcnt lgkmcnt(7)
    v_mfma_f32_32x32x16_bf16 v[64:79], a[4:7], a[16:19], v[64:79]
    ds_read_b64_tr_b16 a[4:5], v11 offset:49152
    ds_read_b64_tr_b16 a[6:7], v11 offset:50176
    s_waitcnt lgkmcnt(7)
    v_mfma_f32_32x32x16_bf16 v[80:95], a[8:11], a[16:19], v[80:95]
    ds_read_b64_tr_b16 a[8:9], v12 offset:49152
    ds_read_b64_tr_b16 a[10:11], v12 offset:50176
    s_waitcnt lgkmcnt(7)
    v_mfma_f32_32x32x16_bf16 v[96:111], a[12:15], a[16:19], v[96:111]
    ds_read_b64_tr_b16 a[12:13], v13 offset:49152
    ds_read_b64_tr_b16 a[14:15], v13 offset:50176
    s_waitcnt lgkmcnt(6)
    v_mfma_f32_32x32x16_bf16 v[48:63], a[0:3], a[20:23], v[48:63]
    s_waitcnt lgkmcnt(4)
    v_mfma_f32_32x32x16_bf16 v[64:79], a[4:7], a[20:23], v[64:79]
    s_waitcnt lgkmcnt(0)
    s_barrier
    ds_read_b128 a[16:19], v6 offset:0
    ds_read_b64_tr_b16 a[0:1], v14 offset:0
    ds_read_b64_tr_b16 a[2:3], v14 offset:1024
    ds_read_b64_tr_b16 a[4:5], v15 offset:0
    ds_read_b64_tr_b16 a[6:7], v15 offset:1024
    v_mfma_f32_32x32x16_bf16 v[80:95], a[8:11], a[20:23], v[80:95]
    ds_read_b64_tr_b16 a[8:9], v16 offset:0
    ds_read_b64_tr_b16 a[10:11], v16 offset:1024
    v_mfma_f32_32x32x16_bf16 v[96:111], a[12:15], a[20:23], v[96:111]
    ds_read_b64_tr_b16 a[12:13], v17 offset:0
    ds_read_b64_tr_b16 a[14:15], v17 offset:1024
    s_waitcnt lgkmcnt(6)
    v_mfma_f32_32x32x16_bf16 v[48:63], a[0:3], a[16:19], v[48:63]
    ds_read_b128 a[20:23], v7 offset:0
    ds_read_b64_tr_b16 a[0:1], v14 offset:4096
    ds_read_b64_tr_b16 a[2:3], v14 offset:5120
    s_waitcnt lgkmcnt(7)
    v_mfma_f32_32x32x16_bf16 v[64:79], a[4:7], a[16:19], v[64:79]
    ds_read_b64_tr_b16 a[4:5], v15 offset:4096
    ds_read_b64_tr_b16 a[6:7], v15 offset:5120
    s_waitcnt lgkmcnt(7)
    v_mfma_f32_32x32x16_bf16 v[80:95], a[8:11], a[16:19], v[80:95]
    ds_read_b64_tr_b16 a[8:9], v16 offset:4096
    ds_read_b64_tr_b16 a[10:11], v16 offset:5120
    s_waitcnt lgkmcnt(7)
    v_mfma_f32_32x32x16_bf16 v[96:111], a[12:15], a[16:19], v[96:111]
    ds_read_b64_tr_b16 a[12:13], v17 offset:4096
    ds_read_b64_tr_b16 a[14:15], v17 offset:5120
    s_waitcnt lgkmcnt(6)
    v_mfma_f32_32x32x16_bf16 v[48:63], a[0:3], a[20:23], v[48:63]
    ds_read_b128 a[16:19], v8 offset:0
    ds_read_b64_tr_b16 a[0:1], v14 offset:8192
    ds_read_b64_tr_b16 a[2:3], v14 offset:9216
    s_waitcnt lgkmcnt(7)
    v_mfma_f32_32x32x16_bf16 v[64:79], a[4:7], a[20:23], v[64:79]
    ds_read_b64_tr_b16 a[4:5], v15 offset:8192
    ds_read_b64_tr_b16 a[6:7], v15 offset:9216
    s_waitcnt lgkmcnt(7)
    v_mfma_f32_32x32x16_bf16 v[80:95], a[8:11], a[20:23], v[80:95]
    ds_read_b64_tr_b16 a[8:9], v16 offset:8192
    ds_read_b64_tr_b16 a[10:11], v16 offset:9216
    s_waitcnt lgkmcnt(7)
    v_mfma_f32_32x32x16_bf16 v[96:111], a[12:15], a[20:23], v[96:111]
    ds_read_b64_tr_b16 a[12:13], v17 offset:8192
    ds_read_b64_tr_b16 a[14:15], v17 offset:9216
    s_waitcnt lgkmcnt(6)
    v_mfma_f32_32x32x16_bf16 v[48:63], a[0:3], a[16:19], v[48:63]
    ds_read_b128 a[20:23], v9 offset:0
    ds_read_b64_tr_b16 a[0:1], v14 offset:12288
    ds_read_b64_tr_b16 a[2:3], v14 offset:13312
    s_waitcnt lgkmcnt(7)
    v_mfma_f32_32x32x16_bf16 v[64:79], a[4:7], a[16:19], v[64:79]
    ds_read_b64_tr_b16 a[4:5], v15 offset:12288
    ds_read_b64_tr_b16 a[6:7], v15 offset:13312
    s_waitcnt lgkmcnt(7)
    v_mfma_f32_32x32x16_bf16 v[80:95], a[8:11], a[16:19], v[80:95]
    ds_read_b64_tr_b16 a[8:9], v16 offset:12288
    ds_read_b64_tr_b16 a[10:11], v16 offset:13312
    s_waitcnt lgkmcnt(7)
    v_mfma_f32_32x32x16_bf16 v[96:111], a[12:15], a[16:19], v[96:111]
    ds_read_b64_tr_b16 a[12:13], v17 offset:12288
    ds_read_b64_tr_b16 a[14:15], v17 offset:13312
    s_waitcnt lgkmcnt(6)
    v_mfma_f32_32x32x16_bf16 v[48:63], a[0:3], a[20:23], v[48:63]
    s_waitcnt lgkmcnt(4)
    v_mfma_f32_32x32x16_bf16 v[64:79], a[4:7], a[20:23], v[64:79]
    s_waitcnt lgkmcnt(0)
    s_barrier
    ds_read_b128 a[16:19], v6 offset:36864
    ds_read_b64_tr_b16 a[0:1], v14 offset:36864
    ds_read_b64_tr_b16 a[2:3], v14 offset:37888
    ds_read_b64_tr_b16 a[4:5], v15 offset:36864
    ds_read_b64_tr_b16 a[6:7], v15 offset:37888
    v_mfma_f32_32x32x16_bf16 v[80:95], a[8:11], a[20:23], v[80:95]
    ds_read_b64_tr_b16 a[8:9], v16 offset:36864
    ds_read_b64_tr_b16 a[10:11], v16 offset:37888
    v_mfma_f32_32x32x16_bf16 v[96:111], a[12:15], a[20:23], v[96:111]
    ds_read_b64_tr_b16 a[12:13], v17 offset:36864
    ds_read_b64_tr_b16 a[14:15], v17 offset:37888
    s_waitcnt lgkmcnt(6)
    v_mfma_f32_32x32x16_bf16 v[48:63], a[0:3], a[16:19], v[48:63]
    ds_read_b128 a[20:23], v7 offset:36864
    ds_read_b64_tr_b16 a[0:1], v14 offset:40960
    ds_read_b64_tr_b16 a[2:3], v14 offset:41984
    s_waitcnt lgkmcnt(7)
    v_mfma_f32_32x32x16_bf16 v[64:79], a[4:7], a[16:19], v[64:79]
    ds_read_b64_tr_b16 a[4:5], v15 offset:40960
    ds_read_b64_tr_b16 a[6:7], v15 offset:41984
    s_waitcnt lgkmcnt(7)
    v_mfma_f32_32x32x16_bf16 v[80:95], a[8:11], a[16:19], v[80:95]
    ds_read_b64_tr_b16 a[8:9], v16 offset:40960
    ds_read_b64_tr_b16 a[10:11], v16 offset:41984
    s_waitcnt lgkmcnt(7)
    v_mfma_f32_32x32x16_bf16 v[96:111], a[12:15], a[16:19], v[96:111]
    ds_read_b64_tr_b16 a[12:13], v17 offset:40960
    ds_read_b64_tr_b16 a[14:15], v17 offset:41984
    s_waitcnt lgkmcnt(6)
    v_mfma_f32_32x32x16_bf16 v[48:63], a[0:3], a[20:23], v[48:63]
    ds_read_b128 a[16:19], v8 offset:36864
    ds_read_b64_tr_b16 a[0:1], v14 offset:45056
    ds_read_b64_tr_b16 a[2:3], v14 offset:46080
    s_waitcnt lgkmcnt(7)
    v_mfma_f32_32x32x16_bf16 v[64:79], a[4:7], a[20:23], v[64:79]
    ds_read_b64_tr_b16 a[4:5], v15 offset:45056
    ds_read_b64_tr_b16 a[6:7], v15 offset:46080
    s_waitcnt lgkmcnt(7)
    v_mfma_f32_32x32x16_bf16 v[80:95], a[8:11], a[20:23], v[80:95]
    ds_read_b64_tr_b16 a[8:9], v16 offset:45056
    ds_read_b64_tr_b16 a[10:11], v16 offset:46080
    s_waitcnt lgkmcnt(7)
    v_mfma_f32_32x32x16_bf16 v[96:111], a[12:15], a[20:23], v[96:111]
    ds_read_b64_tr_b16 a[12:13], v17 offset:45056
    ds_read_b64_tr_b16 a[14:15], v17 offset:46080
    s_waitcnt lgkmcnt(6)
    v_mfma_f32_32x32x16_bf16 v[48:63], a[0:3], a[16:19], v[48:63]
    ds_read_b128 a[20:23], v9 offset:36864
    ds_read_b64_tr_b16 a[0:1], v14 offset:49152
    ds_read_b64_tr_b16 a[2:3], v14 offset:50176
    s_waitcnt lgkmcnt(7)
    v_mfma_f32_32x32x16_bf16 v[64:79], a[4:7], a[16:19], v[64:79]
    ds_read_b64_tr_b16 a[4:5], v15 offset:49152
    ds_read_b64_tr_b16 a[6:7], v15 offset:50176
    s_waitcnt lgkmcnt(7)
    v_mfma_f32_32x32x16_bf16 v[80:95], a[8:11], a[16:19], v[80:95]
    ds_read_b64_tr_b16 a[8:9], v16 offset:49152
    ds_read_b64_tr_b16 a[10:11], v16 offset:50176
    s_waitcnt lgkmcnt(7)
    v_mfma_f32_32x32x16_bf16 v[96:111], a[12:15], a[16:19], v[96:111]
    ds_read_b64_tr_b16 a[12:13], v17 offset:49152
    ds_read_b64_tr_b16 a[14:15], v17 offset:50176
    s_waitcnt lgkmcnt(6)
    v_mfma_f32_32x32x16_bf16 v[48:63], a[0:3], a[20:23], v[48:63]
    s_waitcnt lgkmcnt(4)
    v_mfma_f32_32x32x16_bf16 v[64:79], a[4:7], a[20:23], v[64:79]
    s_waitcnt lgkmcnt(0)
    s_barrier
    ds_read_b128 a[16:19], v2 offset:0
    ds_read_b64_tr_b16 a[0:1], v10 offset:0
    ds_read_b64_tr_b16 a[2:3], v10 offset:1024
    ds_read_b64_tr_b16 a[4:5], v11 offset:0
    ds_read_b64_tr_b16 a[6:7], v11 offset:1024
    v_mfma_f32_32x32x16_bf16 v[80:95], a[8:11], a[20:23], v[80:95]
    ds_read_b64_tr_b16 a[8:9], v12 offset:0
    ds_read_b64_tr_b16 a[10:11], v12 offset:1024
    v_mfma_f32_32x32x16_bf16 v[96:111], a[12:15], a[20:23], v[96:111]
    ds_read_b64_tr_b16 a[12:13], v13 offset:0
    ds_read_b64_tr_b16 a[14:15], v13 offset:1024
    s_waitcnt lgkmcnt(6)
    v_mfma_f32_32x32x16_bf16 v[48:63], a[0:3], a[16:19], v[48:63]
    ds_read_b128 a[20:23], v3 offset:0
    ds_read_b64_tr_b16 a[0:1], v10 offset:4096
    ds_read_b64_tr_b16 a[2:3], v10 offset:5120
    s_waitcnt lgkmcnt(7)
    v_mfma_f32_32x32x16_bf16 v[64:79], a[4:7], a[16:19], v[64:79]
    ds_read_b64_tr_b16 a[4:5], v11 offset:4096
    ds_read_b64_tr_b16 a[6:7], v11 offset:5120
    s_waitcnt lgkmcnt(7)
    v_mfma_f32_32x32x16_bf16 v[80:95], a[8:11], a[16:19], v[80:95]
    ds_read_b64_tr_b16 a[8:9], v12 offset:4096
    ds_read_b64_tr_b16 a[10:11], v12 offset:5120
    s_waitcnt lgkmcnt(7)
    v_mfma_f32_32x32x16_bf16 v[96:111], a[12:15], a[16:19], v[96:111]
    ds_read_b64_tr_b16 a[12:13], v13 offset:4096
    ds_read_b64_tr_b16 a[14:15], v13 offset:5120
    s_waitcnt lgkmcnt(6)
    v_mfma_f32_32x32x16_bf16 v[48:63], a[0:3], a[20:23], v[48:63]
    ds_read_b128 a[16:19], v4 offset:0
    ds_read_b64_tr_b16 a[0:1], v10 offset:8192
    ds_read_b64_tr_b16 a[2:3], v10 offset:9216
    s_waitcnt lgkmcnt(7)
    v_mfma_f32_32x32x16_bf16 v[64:79], a[4:7], a[20:23], v[64:79]
    ds_read_b64_tr_b16 a[4:5], v11 offset:8192
    ds_read_b64_tr_b16 a[6:7], v11 offset:9216
    s_waitcnt lgkmcnt(7)
    v_mfma_f32_32x32x16_bf16 v[80:95], a[8:11], a[20:23], v[80:95]
    ds_read_b64_tr_b16 a[8:9], v12 offset:8192
    ds_read_b64_tr_b16 a[10:11], v12 offset:9216
    s_waitcnt lgkmcnt(7)
    v_mfma_f32_32x32x16_bf16 v[96:111], a[12:15], a[20:23], v[96:111]
    ds_read_b64_tr_b16 a[12:13], v13 offset:8192
    ds_read_b64_tr_b16 a[14:15], v13 offset:9216
    s_waitcnt vmcnt(0)
    s_mov_b32 s70, 1664525
    v_mul_lo_u32 v44, v44, s70
    v_add_u32 v44, 1013904223, v44
    v_and_b32 v26, 3, v1
    v_readlane_b32 s3, v44, s69
    v_lshlrev_b32 v26, 1, v26
    v_sub_u32 v26, 32, v26
    v_mov_b32 v46, s3
    v_alignbit_b32 v26, v46, v46, v26
    v_lshlrev_b32 v28, 1, v26
    v_and_b32 v26, 0x80808080, v26
    v_and_b32 v28, 0x80808080, v28
    s_mov_b32 s70, 0x010c000c
    s_mov_b32 s71, 0x030c020c
    v_perm_b32 v43, v26, v26, s70
    v_perm_b32 v45, v26, v26, s71
    v_perm_b32 v24, v28, v28, s70
    v_perm_b32 v25, v28, v28, s71
    s_add_u32 s72, s65, s80
    s_and_b32 s72, s72, 3
    s_lshl_b32 s72, s72, 2
    s_add_u32 s72, s72, s80
    s_lshl_b32 s72, s72, 1
    s_lshr_b32 s101, 3034112484, s72
    s_and_b32 s101, s101, 3
    s_lshl_b32 s70, s62, 11
    s_add_u32 s70, s70, 147712
    v_add_u32 v35, s70, v34
    s_waitcnt lgkmcnt(6)
    v_mfma_f32_32x32x16_bf16 v[48:63], a[0:3], a[16:19], v[48:63]
    ds_read_b128 a[20:23], v5 offset:0
    ds_read_b64_tr_b16 a[0:1], v10 offset:12288
    ds_read_b64_tr_b16 a[2:3], v10 offset:13312
    s_waitcnt lgkmcnt(7)
    v_mfma_f32_32x32x16_bf16 v[64:79], a[4:7], a[16:19], v[64:79]
    ds_read_b64_tr_b16 a[4:5], v11 offset:12288
    ds_read_b64_tr_b16 a[6:7], v11 offset:13312
    s_waitcnt lgkmcnt(7)
    v_mfma_f32_32x32x16_bf16 v[80:95], a[8:11], a[16:19], v[80:95]
    ds_read_b64_tr_b16 a[8:9], v12 offset:12288
    ds_read_b64_tr_b16 a[10:11], v12 offset:13312
    s_waitcnt lgkmcnt(7)
    v_mfma_f32_32x32x16_bf16 v[96:111], a[12:15], a[16:19], v[96:111]
    ds_read_b64_tr_b16 a[12:13], v13 offset:12288
    ds_read_b64_tr_b16 a[14:15], v13 offset:13312
    s_waitcnt lgkmcnt(6)
    v_mfma_f32_32x32x16_bf16 v[48:63], a[0:3], a[20:23], v[48:63]
    s_waitcnt lgkmcnt(4)
    v_mfma_f32_32x32x16_bf16 v[64:79], a[4:7], a[20:23], v[64:79]
    s_waitcnt lgkmcnt(0)
    s_barrier
    ds_read_b128 a[16:19], v2 offset:36864
    ds_read_b64_tr_b16 a[0:1], v10 offset:36864
    ds_read_b64_tr_b16 a[2:3], v10 offset:37888
    ds_read_b64_tr_b16 a[4:5], v10 offset:40960
    ds_read_b64_tr_b16 a[6:7], v10 offset:41984
    ds_read_b128 a[24:27], v4 offset:36864
    v_mfma_f32_32x32x16_bf16 v[80:95], a[8:11], a[20:23], v[80:95]
    ds_read_b64_tr_b16 a[8:9], v10 offset:45056
    ds_read_b64_tr_b16 a[10:11], v10 offset:46080
    ds_read_b128 a[28:31], v5 offset:36864
    v_mfma_f32_32x32x16_bf16 v[96:111], a[12:15], a[20:23], v[96:111]
    ds_read_b128 a[20:23], v3 offset:36864
    ds_read_b64_tr_b16 a[12:13], v10 offset:49152
    ds_read_b64_tr_b16 a[14:15], v10 offset:50176
    s_waitcnt lgkmcnt(9)
    v_mfma_f32_32x32x16_bf16 v[48:63], a[0:3], a[16:19], v[48:63]
    ds_read_b64_tr_b16 a[0:1], v11 offset:36864
    ds_read_b64_tr_b16 a[2:3], v11 offset:37888
    s_waitcnt lgkmcnt(4)
    v_mfma_f32_32x32x16_bf16 v[48:63], a[4:7], a[20:23], v[48:63]
    ds_read_b64_tr_b16 a[4:5], v11 offset:40960
    ds_read_b64_tr_b16 a[6:7], v11 offset:41984
    v_mfma_f32_32x32x16_bf16 v[48:63], a[8:11], a[24:27], v[48:63]
    ds_read_b64_tr_b16 a[8:9], v11 offset:45056
    ds_read_b64_tr_b16 a[10:11], v11 offset:46080
    s_waitcnt lgkmcnt(6)
    v_mfma_f32_32x32x16_bf16 v[48:63], a[12:15], a[28:31], v[48:63]
    ds_read_b64_tr_b16 a[12:13], v11 offset:49152
    ds_read_b64_tr_b16 a[14:15], v11 offset:50176
    s_waitcnt lgkmcnt(6)
    v_mfma_f32_32x32x16_bf16 v[64:79], a[0:3], a[16:19], v[64:79]
    ds_read_b64_tr_b16 a[0:1], v12 offset:36864
    ds_read_b64_tr_b16 a[2:3], v12 offset:37888
    s_waitcnt lgkmcnt(6)
    v_mfma_f32_32x32x16_bf16 v[64:79], a[4:7], a[20:23], v[64:79]
    ds_read_b64_tr_b16 a[4:5], v12 offset:40960
    ds_read_b64_tr_b16 a[6:7], v12 offset:41984
    s_waitcnt lgkmcnt(6)
    v_mfma_f32_32x32x16_bf16 v[64:79], a[8:11], a[24:27], v[64:79]
    ds_read_b64_tr_b16 a[8:9], v12 offset:45056
    ds_read_b64_tr_b16 a[10:11], v12 offset:46080
    v_cvt_pk_bf16_f32 v112, v48, v49
    v_cvt_pk_bf16_f32 v113, v50, v51
    v_cvt_pk_bf16_f32 v114, v52, v53
    v_cvt_pk_bf16_f32 v115, v54, v55
    v_cvt_pk_bf16_f32 v116, v56, v57
    v_cvt_pk_bf16_f32 v117, v58, v59
    v_cvt_pk_bf16_f32 v118, v60, v61
    v_cvt_pk_bf16_f32 v119, v62, v63
    s_waitcnt lgkmcnt(6)
    v_mfma_f32_32x32x16_bf16 v[64:79], a[12:15], a[28:31], v[64:79]
    ds_read_b64_tr_b16 a[12:13], v12 offset:49152
    ds_read_b64_tr_b16 a[14:15], v12 offset:50176
    s_waitcnt lgkmcnt(6)
    v_mfma_f32_32x32x16_bf16 v[80:95], a[0:3], a[16:19], v[80:95]
    ds_read_b64_tr_b16 a[0:1], v13 offset:36864
    ds_read_b64_tr_b16 a[2:3], v13 offset:37888
    s_waitcnt lgkmcnt(6)
    v_mfma_f32_32x32x16_bf16 v[80:95], a[4:7], a[20:23], v[80:95]
    ds_read_b64_tr_b16 a[4:5], v13 offset:40960
    ds_read_b64_tr_b16 a[6:7], v13 offset:41984
    s_waitcnt lgkmcnt(6)
    v_mfma_f32_32x32x16_bf16 v[80:95], a[8:11], a[24:27], v[80:95]
    ds_read_b64_tr_b16 a[8:9], v13 offset:45056
    ds_read_b64_tr_b16 a[10:11], v13 offset:46080
    v_cvt_pk_bf16_f32 v120, v64, v65
    v_cvt_pk_bf16_f32 v121, v66, v67
    v_cvt_pk_bf16_f32 v122, v68, v69
    v_cvt_pk_bf16_f32 v123, v70, v71
    v_cvt_pk_bf16_f32 v124, v72, v73
    v_cvt_pk_bf16_f32 v125, v74, v75
    v_cvt_pk_bf16_f32 v126, v76, v77
    v_cvt_pk_bf16_f32 v127, v78, v79
    s_waitcnt lgkmcnt(6)
    v_mfma_f32_32x32x16_bf16 v[80:95], a[12:15], a[28:31], v[80:95]
    ds_read_b64_tr_b16 a[12:13], v13 offset:49152
    ds_read_b64_tr_b16 a[14:15], v13 offset:50176
    s_waitcnt lgkmcnt(6)
    v_mfma_f32_32x32x16_bf16 v[96:111], a[0:3], a[16:19], v[96:111]
    s_waitcnt lgkmcnt(4)
    v_mfma_f32_32x32x16_bf16 v[96:111], a[4:7], a[20:23], v[96:111]
    s_waitcnt lgkmcnt(0)
    s_nop 3
    s_nop 0
    v_mfma_f32_32x32x16_bf16 v[96:111], a[8:11], a[24:27], v[96:111]
    v_cvt_pk_bf16_f32 v128, v80, v81
    v_cvt_pk_bf16_f32 v129, v82, v83
    v_cvt_pk_bf16_f32 v130, v84, v85
    v_cvt_pk_bf16_f32 v131, v86, v87
    v_cvt_pk_bf16_f32 v132, v88, v89
    v_cvt_pk_bf16_f32 v133, v90, v91
    v_cvt_pk_bf16_f32 v134, v92, v93
    v_cvt_pk_bf16_f32 v135, v94, v95
    v_mfma_f32_32x32x16_bf16 v[96:111], a[12:15], a[28:31], v[96:111]
    v_mfma_f32_32x32x16_bf16 v[144:159], a[32:35], v[112:115], 0
    v_mfma_f32_32x32x16_bf16 v[144:159], a[36:39], v[116:119], v[144:159]
    v_mfma_f32_32x32x16_bf16 v[144:159], a[40:43], v[120:123], v[144:159]
    v_mfma_f32_32x32x16_bf16 v[144:159], a[44:47], v[124:127], v[144:159]
    v_mfma_f32_32x32x16_bf16 v[144:159], a[48:51], v[128:131], v[144:159]
    v_mfma_f32_32x32x16_bf16 v[144:159], a[52:55], v[132:135], v[144:159]
    s_nop 5
    v_cvt_pk_bf16_f32 v136, v96, v97
    v_cvt_pk_bf16_f32 v137, v98, v99
    v_cvt_pk_bf16_f32 v138, v100, v101
    v_cvt_pk_bf16_f32 v139, v102, v103
    v_cvt_pk_bf16_f32 v140, v104, v105
    v_cvt_pk_bf16_f32 v141, v106, v107
    v_cvt_pk_bf16_f32 v142, v108, v109
    v_cvt_pk_bf16_f32 v143, v110, v111
    s_nop 0
    v_mfma_f32_32x32x16_bf16 v[144:159], a[56:59], v[136:139], v[144:159]
    v_mfma_f32_32x32x16_bf16 v[144:159], a[60:63], v[140:143], v[144:159]
    s_nop 11
    v_max3_f32 v30, v144, v145, v146
    v_max3_f32 v31, v147, v148, v149
    v_max3_f32 v30, v30, v150, v151
    v_max3_f32 v31, v31, v152, v153
    v_max3_f32 v30, v30, v154, v155
    v_max3_f32 v31, v31, v156, v157
    v_max3_f32 v30, v30, v158, v159
    v_max_f32 v30, v30, v31
    v_mov_b32 v31, v30
    s_nop 1
    v_permlane32_swap_b32 v30, v31
    s_nop 1
    v_max_f32 v30, v30, v31
    v_mul_f32 v30, s77, v30
    v_mov_b32 v31, v30
    v_pk_fma_f32 v[144:145], v[144:145], s[52:53], v[30:31] neg_lo:[0,0,1] neg_hi:[0,0,1]
    v_pk_fma_f32 v[146:147], v[146:147], s[52:53], v[30:31] neg_lo:[0,0,1] neg_hi:[0,0,1]
    v_pk_fma_f32 v[148:149], v[148:149], s[52:53], v[30:31] neg_lo:[0,0,1] neg_hi:[0,0,1]
    v_pk_fma_f32 v[150:151], v[150:151], s[52:53], v[30:31] neg_lo:[0,0,1] neg_hi:[0,0,1]
    v_pk_fma_f32 v[152:153], v[152:153], s[52:53], v[30:31] neg_lo:[0,0,1] neg_hi:[0,0,1]
    v_pk_fma_f32 v[154:155], v[154:155], s[52:53], v[30:31] neg_lo:[0,0,1] neg_hi:[0,0,1]
    v_pk_fma_f32 v[156:157], v[156:157], s[52:53], v[30:31] neg_lo:[0,0,1] neg_hi:[0,0,1]
    v_pk_fma_f32 v[158:159], v[158:159], s[52:53], v[30:31] neg_lo:[0,0,1] neg_hi:[0,0,1]
    v_exp_f32 v144, v144
    v_exp_f32 v145, v145
    v_exp_f32 v146, v146
    v_exp_f32 v147, v147
    v_exp_f32 v148, v148
    v_exp_f32 v149, v149
    v_exp_f32 v150, v150
    v_exp_f32 v151, v151
    v_exp_f32 v152, v152
    v_exp_f32 v153, v153
    v_exp_f32 v154, v154
    v_exp_f32 v155, v155
    v_exp_f32 v156, v156
    v_exp_f32 v157, v157
    v_exp_f32 v158, v158
    v_exp_f32 v159, v159
    s_nop 0
    v_pk_add_f32 v[30:31], v[144:145], v[146:147]
    v_pk_add_f32 v[112:113], v[148:149], v[150:151]
    v_pk_add_f32 v[30:31], v[30:31], v[152:153]
    v_pk_add_f32 v[112:113], v[112:113], v[154:155]
    v_pk_add_f32 v[30:31], v[30:31], v[156:157]
    v_pk_add_f32 v[112:113], v[112:113], v[158:159]
    v_pk_add_f32 v[30:31], v[30:31], v[112:113]
    v_add_f32 v30, v30, v31
    v_mov_b32 v31, v30
    s_nop 1
    v_permlane32_swap_b32 v30, v31
    s_nop 1
    v_add_f32 v30, v30, v31
    v_rcp_f32 v30, v30
    s_nop 0
    v_mov_b32 v31, v30
    v_pk_mul_f32 v[144:145], v[144:145], v[30:31]
    v_pk_mul_f32 v[146:147], v[146:147], v[30:31]
    v_pk_mul_f32 v[148:149], v[148:149], v[30:31]
    v_pk_mul_f32 v[150:151], v[150:151], v[30:31]
    v_pk_mul_f32 v[152:153], v[152:153], v[30:31]
    v_pk_mul_f32 v[154:155], v[154:155], v[30:31]
    v_pk_mul_f32 v[156:157], v[156:157], v[30:31]
    v_pk_mul_f32 v[158:159], v[158:159], v[30:31]
    v_cvt_pk_bf16_f32 v112, v144, v145
    v_cvt_pk_bf16_f32 v113, v146, v147
    v_cvt_pk_bf16_f32 v114, v152, v153
    v_cvt_pk_bf16_f32 v115, v154, v155
    v_cvt_pk_bf16_f32 v116, v148, v149
    v_cvt_pk_bf16_f32 v117, v150, v151
    v_cvt_pk_bf16_f32 v118, v156, v157
    v_cvt_pk_bf16_f32 v119, v158, v159
    ds_write_b128 v35, v[112:115]
    ds_write_b128 v35, v[116:119] offset:512
    v_and_or_b32 v144, v112, s36, v43
    v_and_or_b32 v145, v113, s36, v45
    v_and_or_b32 v146, v114, s36, v24
    v_and_or_b32 v147, v115, s36, v25
    v_and_or_b32 v148, v116, s36, v43
    v_and_or_b32 v149, v117, s36, v45
    v_and_or_b32 v150, v118, s36, v24
    v_and_or_b32 v151, v119, s36, v25
    buffer_store_dwordx4 v[144:147], v34, s[20:23], s78 offen sc1
    buffer_store_dwordx4 v[148:151], v34, s[20:23], s78 offen offset:512 sc1
    v_mov_b32 v35, 0
    s_barrier
    ds_read_b128 a[56:59], v36 offset:0
    ds_read_b128 a[72:75], v36 offset:4096
    ds_read_b64_tr_b16 a[32:33], v40 offset:0
    ds_read_b64_tr_b16 a[34:35], v40 offset:2304
    ds_read_b128 a[60:63], v37 offset:0
    ds_read_b128 a[76:79], v37 offset:4096
    ds_read_b64_tr_b16 a[36:37], v40 offset:9216
    ds_read_b64_tr_b16 a[38:39], v40 offset:11520
    ds_read_b128 a[64:67], v38 offset:0
    ds_read_b128 a[80:83], v38 offset:4096
    ds_read_b64_tr_b16 a[40:41], v40 offset:18432
    ds_read_b64_tr_b16 a[42:43], v40 offset:20736
    ds_read_b128 a[68:71], v39 offset:0
    ds_read_b128 a[84:87], v39 offset:4096
    ds_read_b64_tr_b16 a[44:45], v40 offset:27648
    ds_read_b64_tr_b16 a[46:47], v40 offset:29952
    ds_read_b64_tr_b16 a[48:49], v40 offset:32
    ds_read_b64_tr_b16 a[50:51], v40 offset:2336
    ds_read_b64_tr_b16 a[52:53], v40 offset:9248
    ds_read_b64_tr_b16 a[54:55], v40 offset:11552
    v_lshlrev_b32 v34, 3, v1
    v_add_u32 v34, 4096, v34
    v_mov_b32 v30, 147456
    v_mov_b32 v28, 1
    s_lshl_b32 s70, s6, 2
    s_add_u32 s70, s70, s62
    s_lshl_b32 s70, s70, 4
    s_add_u32 s70, s70, s69
    s_lshl_b32 s70, s70, 7
    s_add_u32 s70, s70, 14680064
    v_lshl_add_u32 v29, v1, 10, s70
    v_add_u32 v45, 110592, v42
    v_add_u32 v43, 110592, v34
    s_cmp_eq_u32 s62, s64
    s_cselect_b32 s54, s81, 7
    s_lshl_b32 s76, s62, 11
    s_add_u32 s76, s76, 147712
    v_add_u32 v33, s83, v42
    v_add_u32 v33, 73728, v33
    s_waitcnt lgkmcnt(15)
    v_mfma_f32_16x16x32_bf16 v[2:5], a[56:59], a[32:35], 0
    v_mfma_f32_16x16x32_bf16 v[6:9], a[72:75], a[32:35], 0
    ds_read_b64_tr_b16 a[32:33], v40 offset:18464
    ds_read_b64_tr_b16 a[34:35], v40 offset:20768
    s_waitcnt lgkmcnt(14)
    v_mfma_f32_16x16x32_bf16 v[2:5], a[60:63], a[36:39], v[2:5]
    v_mfma_f32_16x16x32_bf16 v[6:9], a[76:79], a[36:39], v[6:9]
    ds_read_b64_tr_b16 a[36:37], v40 offset:27680
    ds_read_b64_tr_b16 a[38:39], v40 offset:29984
    s_waitcnt lgkmcnt(12)
    v_mfma_f32_16x16x32_bf16 v[2:5], a[64:67], a[40:43], v[2:5]
    v_mfma_f32_16x16x32_bf16 v[6:9], a[80:83], a[40:43], v[6:9]
    ds_read_b64_tr_b16 a[40:41], v40 offset:64
    ds_read_b64_tr_b16 a[42:43], v40 offset:2368
    s_waitcnt lgkmcnt(10)
    v_mfma_f32_16x16x32_bf16 v[2:5], a[68:71], a[44:47], v[2:5]
    v_mfma_f32_16x16x32_bf16 v[6:9], a[84:87], a[44:47], v[6:9]
    ds_read_b64_tr_b16 a[44:45], v40 offset:9280
    ds_read_b64_tr_b16 a[46:47], v40 offset:11584
    s_waitcnt lgkmcnt(10)
    v_mfma_f32_16x16x32_bf16 v[10:13], a[56:59], a[48:51], 0
    v_mfma_f32_16x16x32_bf16 v[14:17], a[72:75], a[48:51], 0
    ds_read_b64_tr_b16 a[48:49], v40 offset:18496
    s_waitcnt lgkmcnt(9)
    v_mfma_f32_16x16x32_bf16 v[10:13], a[60:63], a[52:55], v[10:13]
    ds_read_b64_tr_b16 a[50:51], v40 offset:20800
    v_mfma_f32_16x16x32_bf16 v[14:17], a[76:79], a[52:55], v[14:17]
    ds_read_b64_tr_b16 a[52:53], v40 offset:27712
    s_waitcnt lgkmcnt(9)
    v_mfma_f32_16x16x32_bf16 v[10:13], a[64:67], a[32:35], v[10:13]
    ds_read_b64_tr_b16 a[54:55], v40 offset:30016
    v_cvt_pk_bf16_f32 v60, v2, v3
    v_mfma_f32_16x16x32_bf16 v[14:17], a[80:83], a[32:35], v[14:17]
    ds_read_b64_tr_b16 a[32:33], v40 offset:96
    v_cvt_pk_bf16_f32 v61, v4, v5
    s_waitcnt lgkmcnt(9)
    v_mfma_f32_16x16x32_bf16 v[10:13], a[68:71], a[36:39], v[10:13]
    ds_read_b64_tr_b16 a[34:35], v40 offset:2400
    v_cvt_pk_bf16_f32 v62, v6, v7
    v_mfma_f32_16x16x32_bf16 v[14:17], a[84:87], a[36:39], v[14:17]
    ds_read_b64_tr_b16 a[36:37], v40 offset:9312
    v_cvt_pk_bf16_f32 v63, v8, v9
    s_waitcnt lgkmcnt(9)
    v_mfma_f32_16x16x32_bf16 v[2:5], a[56:59], a[40:43], 0
    ds_read_b64_tr_b16 a[38:39], v40 offset:11616
    v_mfma_f32_16x16x32_bf16 v[6:9], a[72:75], a[40:43], 0
    ds_read_b64_tr_b16 a[40:41], v40 offset:18528
    s_waitcnt lgkmcnt(9)
    v_mfma_f32_16x16x32_bf16 v[2:5], a[60:63], a[44:47], v[2:5]
    ds_read_b64_tr_b16 a[42:43], v40 offset:20832
    v_mfma_f32_16x16x32_bf16 v[6:9], a[76:79], a[44:47], v[6:9]
    ds_read_b64_tr_b16 a[44:45], v40 offset:27744
    s_waitcnt lgkmcnt(9)
    v_mfma_f32_16x16x32_bf16 v[2:5], a[64:67], a[48:51], v[2:5]
    ds_read_b64_tr_b16 a[46:47], v40 offset:30048
    v_cvt_pk_bf16_f32 v72, v10, v11
    v_mfma_f32_16x16x32_bf16 v[6:9], a[80:83], a[48:51], v[6:9]
    ds_read_b64_tr_b16 a[48:49], v40 offset:128
    v_cvt_pk_bf16_f32 v73, v12, v13
    s_waitcnt lgkmcnt(9)
    v_mfma_f32_16x16x32_bf16 v[2:5], a[68:71], a[52:55], v[2:5]
    ds_read_b64_tr_b16 a[50:51], v40 offset:2432
    v_cvt_pk_bf16_f32 v74, v14, v15
    v_mfma_f32_16x16x32_bf16 v[6:9], a[84:87], a[52:55], v[6:9]
    ds_read_b64_tr_b16 a[52:53], v40 offset:9344
    v_cvt_pk_bf16_f32 v75, v16, v17
    s_waitcnt lgkmcnt(9)
    v_mfma_f32_16x16x32_bf16 v[10:13], a[56:59], a[32:35], 0
    ds_read_b64_tr_b16 a[54:55], v40 offset:11648
    v_mfma_f32_16x16x32_bf16 v[14:17], a[72:75], a[32:35], 0
    ds_read_b64_tr_b16 a[32:33], v40 offset:18560
    s_waitcnt lgkmcnt(9)
    v_mfma_f32_16x16x32_bf16 v[10:13], a[60:63], a[36:39], v[10:13]
    ds_read_b64_tr_b16 a[34:35], v40 offset:20864
    v_mfma_f32_16x16x32_bf16 v[14:17], a[76:79], a[36:39], v[14:17]
    ds_read_b64_tr_b16 a[36:37], v40 offset:27776
    s_waitcnt lgkmcnt(9)
    v_mfma_f32_16x16x32_bf16 v[10:13], a[64:67], a[40:43], v[10:13]
    ds_read_b64_tr_b16 a[38:39], v40 offset:30080
    v_cvt_pk_bf16_f32 v84, v2, v3
    v_mfma_f32_16x16x32_bf16 v[14:17], a[80:83], a[40:43], v[14:17]
    ds_read_b64_tr_b16 a[40:41], v40 offset:160
    v_cvt_pk_bf16_f32 v85, v4, v5
    s_waitcnt lgkmcnt(9)
    v_mfma_f32_16x16x32_bf16 v[10:13], a[68:71], a[44:47], v[10:13]
    ds_read_b64_tr_b16 a[42:43], v40 offset:2464
    v_cvt_pk_bf16_f32 v86, v6, v7
    v_mfma_f32_16x16x32_bf16 v[14:17], a[84:87], a[44:47], v[14:17]
    ds_read_b64_tr_b16 a[44:45], v40 offset:9376
    v_cvt_pk_bf16_f32 v87, v8, v9
    s_barrier
    s_waitcnt lgkmcnt(9)
    v_mfma_f32_16x16x32_bf16 v[2:5], a[56:59], a[48:51], 0
    ds_read_b64_tr_b16 a[46:47], v40 offset:11680
    v_mfma_f32_16x16x32_bf16 v[6:9], a[72:75], a[48:51], 0
    ds_read_b64_tr_b16 a[48:49], v40 offset:18592
    s_waitcnt lgkmcnt(9)
    v_mfma_f32_16x16x32_bf16 v[2:5], a[60:63], a[52:55], v[2:5]
    ds_read_b64_tr_b16 a[50:51], v40 offset:20896
    v_mfma_f32_16x16x32_bf16 v[6:9], a[76:79], a[52:55], v[6:9]
    ds_read_b64_tr_b16 a[52:53], v40 offset:27808
    s_waitcnt lgkmcnt(9)
    v_mfma_f32_16x16x32_bf16 v[2:5], a[64:67], a[32:35], v[2:5]
    ds_read_b64_tr_b16 a[54:55], v40 offset:30112
    v_cvt_pk_bf16_f32 v96, v10, v11
    v_mfma_f32_16x16x32_bf16 v[6:9], a[80:83], a[32:35], v[6:9]
    ds_read_b64_tr_b16 a[32:33], v40 offset:192
    v_cvt_pk_bf16_f32 v97, v12, v13
    s_waitcnt lgkmcnt(9)
    v_mfma_f32_16x16x32_bf16 v[2:5], a[68:71], a[36:39], v[2:5]
    ds_read_b64_tr_b16 a[34:35], v40 offset:2496
    v_cvt_pk_bf16_f32 v98, v14, v15
    v_mfma_f32_16x16x32_bf16 v[6:9], a[84:87], a[36:39], v[6:9]
    ds_read_b64_tr_b16 a[36:37], v40 offset:9408
    v_cvt_pk_bf16_f32 v99, v16, v17
    s_waitcnt lgkmcnt(9)
    v_mfma_f32_16x16x32_bf16 v[10:13], a[56:59], a[40:43], 0
    ds_read_b64_tr_b16 a[38:39], v40 offset:11712
    v_mfma_f32_16x16x32_bf16 v[14:17], a[72:75], a[40:43], 0
    ds_read_b64_tr_b16 a[40:41], v40 offset:18624
    s_waitcnt lgkmcnt(9)
    v_mfma_f32_16x16x32_bf16 v[10:13], a[60:63], a[44:47], v[10:13]
    ds_read_b64_tr_b16 a[42:43], v40 offset:20928
    v_mfma_f32_16x16x32_bf16 v[14:17], a[76:79], a[44:47], v[14:17]
    ds_read_b64_tr_b16 a[44:45], v40 offset:27840
    s_waitcnt lgkmcnt(9)
    v_mfma_f32_16x16x32_bf16 v[10:13], a[64:67], a[48:51], v[10:13]
    ds_read_b64_tr_b16 a[46:47], v40 offset:30144
    v_cvt_pk_bf16_f32 v108, v2, v3
    v_mfma_f32_16x16x32_bf16 v[14:17], a[80:83], a[48:51], v[14:17]
    ds_read_b64_tr_b16 a[48:49], v40 offset:224
    v_cvt_pk_bf16_f32 v109, v4, v5
    s_waitcnt lgkmcnt(9)
    v_mfma_f32_16x16x32_bf16 v[10:13], a[68:71], a[52:55], v[10:13]
    ds_read_b64_tr_b16 a[50:51], v40 offset:2528
    v_cvt_pk_bf16_f32 v110, v6, v7
    v_mfma_f32_16x16x32_bf16 v[14:17], a[84:87], a[52:55], v[14:17]
    ds_read_b64_tr_b16 a[52:53], v40 offset:9440
    v_cvt_pk_bf16_f32 v111, v8, v9
    s_waitcnt lgkmcnt(9)
    v_mfma_f32_16x16x32_bf16 v[2:5], a[56:59], a[32:35], 0
    ds_read_b64_tr_b16 a[54:55], v40 offset:11744
    v_mfma_f32_16x16x32_bf16 v[6:9], a[72:75], a[32:35], 0
    ds_read_b64_tr_b16 a[32:33], v40 offset:18656
    s_waitcnt lgkmcnt(9)
    v_mfma_f32_16x16x32_bf16 v[2:5], a[60:63], a[36:39], v[2:5]
    ds_read_b64_tr_b16 a[34:35], v40 offset:20960
    v_mfma_f32_16x16x32_bf16 v[6:9], a[76:79], a[36:39], v[6:9]
    ds_read_b64_tr_b16 a[36:37], v40 offset:27872
    s_waitcnt lgkmcnt(9)
    v_mfma_f32_16x16x32_bf16 v[2:5], a[64:67], a[40:43], v[2:5]
    ds_read_b64_tr_b16 a[38:39], v40 offset:30176
    v_cvt_pk_bf16_f32 v120, v10, v11
    v_mfma_f32_16x16x32_bf16 v[6:9], a[80:83], a[40:43], v[6:9]
    ds_read_b64_tr_b16 a[40:41], v40 offset:256
    v_cvt_pk_bf16_f32 v121, v12, v13
    s_waitcnt lgkmcnt(9)
    v_mfma_f32_16x16x32_bf16 v[2:5], a[68:71], a[44:47], v[2:5]
    ds_read_b64_tr_b16 a[42:43], v40 offset:2560
    v_cvt_pk_bf16_f32 v122, v14, v15
    v_mfma_f32_16x16x32_bf16 v[6:9], a[84:87], a[44:47], v[6:9]
    ds_read_b64_tr_b16 a[44:45], v40 offset:9472
    v_cvt_pk_bf16_f32 v123, v16, v17
    s_waitcnt lgkmcnt(9)
    v_mfma_f32_16x16x32_bf16 v[10:13], a[56:59], a[48:51], 0
    ds_read_b64_tr_b16 a[46:47], v40 offset:11776
    v_mfma_f32_16x16x32_bf16 v[14:17], a[72:75], a[48:51], 0
    ds_read_b64_tr_b16 a[48:49], v40 offset:18688
    s_waitcnt lgkmcnt(9)
    v_mfma_f32_16x16x32_bf16 v[10:13], a[60:63], a[52:55], v[10:13]
    ds_read_b64_tr_b16 a[50:51], v40 offset:20992
    v_mfma_f32_16x16x32_bf16 v[14:17], a[76:79], a[52:55], v[14:17]
    ds_read_b64_tr_b16 a[52:53], v40 offset:27904
    s_waitcnt lgkmcnt(9)
    v_mfma_f32_16x16x32_bf16 v[10:13], a[64:67], a[32:35], v[10:13]
    ds_read_b64_tr_b16 a[54:55], v40 offset:30208
    v_cvt_pk_bf16_f32 v132, v2, v3
    v_mfma_f32_16x16x32_bf16 v[14:17], a[80:83], a[32:35], v[14:17]
    v_cvt_pk_bf16_f32 v133, v4, v5
    s_waitcnt lgkmcnt(8)
    v_mfma_f32_16x16x32_bf16 v[10:13], a[68:71], a[36:39], v[10:13]
    v_cvt_pk_bf16_f32 v134, v6, v7
    v_mfma_f32_16x16x32_bf16 v[14:17], a[84:87], a[36:39], v[14:17]
    v_cvt_pk_bf16_f32 v135, v8, v9
    s_waitcnt lgkmcnt(6)
    v_mfma_f32_16x16x32_bf16 v[2:5], a[56:59], a[40:43], 0
    v_mfma_f32_16x16x32_bf16 v[6:9], a[72:75], a[40:43], 0
    s_waitcnt lgkmcnt(0)
    s_barrier
    v_add_u32 v31, 4294893568, v36
    ds_read_b128 a[56:59], v31 offset:0
    ds_read_b128 a[72:75], v31 offset:4096
    ds_read_b64_tr_b16 a[32:33], v41 offset:0
    ds_read_b64_tr_b16 a[34:35], v41 offset:2304
    ds_read_b64_tr_b16 a[36:37], v41 offset:9216
    ds_read_b64_tr_b16 a[38:39], v41 offset:11520
    v_mfma_f32_16x16x32_bf16 v[2:5], a[60:63], a[44:47], v[2:5]
    ds_read_b64_tr_b16 a[40:41], v41 offset:18432
    ds_read_b64_tr_b16 a[42:43], v41 offset:20736
    v_mfma_f32_16x16x32_bf16 v[6:9], a[76:79], a[44:47], v[6:9]
    v_add_u32 v31, 4294893568, v37
    ds_read_b128 a[60:63], v31 offset:0
    ds_read_b128 a[76:79], v31 offset:4096
    v_mfma_f32_16x16x32_bf16 v[2:5], a[64:67], a[48:51], v[2:5]
    ds_read_b64_tr_b16 a[44:45], v41 offset:27648
    ds_read_b64_tr_b16 a[46:47], v41 offset:29952
    v_cvt_pk_bf16_f32 v144, v10, v11
    v_mfma_f32_16x16x32_bf16 v[6:9], a[80:83], a[48:51], v[6:9]
    v_add_u32 v31, 4294893568, v38
    ds_read_b128 a[64:67], v31 offset:0
    ds_read_b128 a[80:83], v31 offset:4096
    v_cvt_pk_bf16_f32 v145, v12, v13
    v_mfma_f32_16x16x32_bf16 v[2:5], a[68:71], a[52:55], v[2:5]
    ds_read_b64_tr_b16 a[48:49], v41 offset:32
    ds_read_b64_tr_b16 a[50:51], v41 offset:2336
    v_cvt_pk_bf16_f32 v146, v14, v15
    v_mfma_f32_16x16x32_bf16 v[6:9], a[84:87], a[52:55], v[6:9]
    v_add_u32 v31, 4294893568, v39
    ds_read_b128 a[68:71], v31 offset:0
    ds_read_b128 a[84:87], v31 offset:4096
    v_cvt_pk_bf16_f32 v147, v16, v17
    s_waitcnt lgkmcnt(14)
    v_mfma_f32_16x16x32_bf16 v[10:13], a[56:59], a[32:35], 0
    ds_read_b64_tr_b16 a[52:53], v41 offset:9248
    ds_read_b64_tr_b16 a[54:55], v41 offset:11552
    v_mfma_f32_16x16x32_bf16 v[14:17], a[72:75], a[32:35], 0
    ds_read_b64_tr_b16 a[32:33], v41 offset:18464
    ds_read_b64_tr_b16 a[34:35], v41 offset:20768
    s_waitcnt lgkmcnt(12)
    v_mfma_f32_16x16x32_bf16 v[10:13], a[60:63], a[36:39], v[10:13]
    v_mfma_f32_16x16x32_bf16 v[14:17], a[76:79], a[36:39], v[14:17]
    ds_read_b64_tr_b16 a[36:37], v41 offset:27680
    ds_read_b64_tr_b16 a[38:39], v41 offset:29984
    s_waitcnt lgkmcnt(10)
    v_mfma_f32_16x16x32_bf16 v[10:13], a[64:67], a[40:43], v[10:13]
    v_cvt_pk_bf16_f32 v156, v2, v3
    v_mfma_f32_16x16x32_bf16 v[14:17], a[80:83], a[40:43], v[14:17]
    ds_read_b64_tr_b16 a[40:41], v41 offset:64
    ds_read_b64_tr_b16 a[42:43], v41 offset:2368
    v_cvt_pk_bf16_f32 v157, v4, v5
    s_waitcnt lgkmcnt(8)
    v_mfma_f32_16x16x32_bf16 v[10:13], a[68:71], a[44:47], v[10:13]
    v_cvt_pk_bf16_f32 v158, v6, v7
    v_mfma_f32_16x16x32_bf16 v[14:17], a[84:87], a[44:47], v[14:17]
    ds_read_b64_tr_b16 a[44:45], v41 offset:9280
    ds_read_b64_tr_b16 a[46:47], v41 offset:11584
    v_cvt_pk_bf16_f32 v159, v8, v9
    v_mfma_f32_16x16x32_bf16 v[2:5], a[56:59], a[48:51], 0
    v_mfma_f32_16x16x32_bf16 v[6:9], a[72:75], a[48:51], 0
    ds_read_b64_tr_b16 a[48:49], v41 offset:18496
    s_waitcnt lgkmcnt(9)
    v_mfma_f32_16x16x32_bf16 v[2:5], a[60:63], a[52:55], v[2:5]
    ds_read_b64_tr_b16 a[50:51], v41 offset:20800
    v_mfma_f32_16x16x32_bf16 v[6:9], a[76:79], a[52:55], v[6:9]
    ds_read_b64_tr_b16 a[52:53], v41 offset:27712
    s_waitcnt lgkmcnt(9)
    v_mfma_f32_16x16x32_bf16 v[2:5], a[64:67], a[32:35], v[2:5]
    ds_read_b64_tr_b16 a[54:55], v41 offset:30016
    v_cvt_pk_bf16_f32 v64, v10, v11
    v_mfma_f32_16x16x32_bf16 v[6:9], a[80:83], a[32:35], v[6:9]
    ds_read_b64_tr_b16 a[32:33], v41 offset:96
    v_cvt_pk_bf16_f32 v65, v12, v13
    s_waitcnt lgkmcnt(9)
    v_mfma_f32_16x16x32_bf16 v[2:5], a[68:71], a[36:39], v[2:5]
    ds_read_b64_tr_b16 a[34:35], v41 offset:2400
    v_cvt_pk_bf16_f32 v66, v14, v15
    v_mfma_f32_16x16x32_bf16 v[6:9], a[84:87], a[36:39], v[6:9]
    ds_read_b64_tr_b16 a[36:37], v41 offset:9312
    v_cvt_pk_bf16_f32 v67, v16, v17
    s_waitcnt lgkmcnt(9)
    v_mfma_f32_16x16x32_bf16 v[10:13], a[56:59], a[40:43], 0
    ds_read_b64_tr_b16 a[38:39], v41 offset:11616
    v_mfma_f32_16x16x32_bf16 v[14:17], a[72:75], a[40:43], 0
    ds_read_b64_tr_b16 a[40:41], v41 offset:18528
    s_waitcnt lgkmcnt(9)
    v_mfma_f32_16x16x32_bf16 v[10:13], a[60:63], a[44:47], v[10:13]
    ds_read_b64_tr_b16 a[42:43], v41 offset:20832
    v_mfma_f32_16x16x32_bf16 v[14:17], a[76:79], a[44:47], v[14:17]
    ds_read_b64_tr_b16 a[44:45], v41 offset:27744
    s_waitcnt lgkmcnt(9)
    v_mfma_f32_16x16x32_bf16 v[10:13], a[64:67], a[48:51], v[10:13]
    ds_read_b64_tr_b16 a[46:47], v41 offset:30048
    v_cvt_pk_bf16_f32 v76, v2, v3
    v_mfma_f32_16x16x32_bf16 v[14:17], a[80:83], a[48:51], v[14:17]
    ds_read_b64_tr_b16 a[48:49], v41 offset:128
    v_cvt_pk_bf16_f32 v77, v4, v5
    s_waitcnt lgkmcnt(9)
    v_mfma_f32_16x16x32_bf16 v[10:13], a[68:71], a[52:55], v[10:13]
    ds_read_b64_tr_b16 a[50:51], v41 offset:2432
    v_cvt_pk_bf16_f32 v78, v6, v7
    v_mfma_f32_16x16x32_bf16 v[14:17], a[84:87], a[52:55], v[14:17]
    ds_read_b64_tr_b16 a[52:53], v41 offset:9344
    v_cvt_pk_bf16_f32 v79, v8, v9
    s_waitcnt lgkmcnt(9)
    v_mfma_f32_16x16x32_bf16 v[2:5], a[56:59], a[32:35], 0
    ds_read_b64_tr_b16 a[54:55], v41 offset:11648
    v_mfma_f32_16x16x32_bf16 v[6:9], a[72:75], a[32:35], 0
    ds_read_b64_tr_b16 a[32:33], v41 offset:18560
    s_waitcnt lgkmcnt(9)
    v_mfma_f32_16x16x32_bf16 v[2:5], a[60:63], a[36:39], v[2:5]
    ds_read_b64_tr_b16 a[34:35], v41 offset:20864
    v_mfma_f32_16x16x32_bf16 v[6:9], a[76:79], a[36:39], v[6:9]
    ds_read_b64_tr_b16 a[36:37], v41 offset:27776
    s_waitcnt lgkmcnt(9)
    v_mfma_f32_16x16x32_bf16 v[2:5], a[64:67], a[40:43], v[2:5]
    ds_read_b64_tr_b16 a[38:39], v41 offset:30080
    v_cvt_pk_bf16_f32 v88, v10, v11
    v_mfma_f32_16x16x32_bf16 v[6:9], a[80:83], a[40:43], v[6:9]
    ds_read_b64_tr_b16 a[40:41], v41 offset:160
    v_cvt_pk_bf16_f32 v89, v12, v13
    s_waitcnt lgkmcnt(9)
    v_mfma_f32_16x16x32_bf16 v[2:5], a[68:71], a[44:47], v[2:5]
    ds_read_b64_tr_b16 a[42:43], v41 offset:2464
    v_cvt_pk_bf16_f32 v90, v14, v15
    v_mfma_f32_16x16x32_bf16 v[6:9], a[84:87], a[44:47], v[6:9]
    ds_read_b64_tr_b16 a[44:45], v41 offset:9376
    v_cvt_pk_bf16_f32 v91, v16, v17
    s_waitcnt lgkmcnt(9)
    v_mfma_f32_16x16x32_bf16 v[10:13], a[56:59], a[48:51], 0
    ds_read_b64_tr_b16 a[46:47], v41 offset:11680
    v_mfma_f32_16x16x32_bf16 v[14:17], a[72:75], a[48:51], 0
    ds_read_b64_tr_b16 a[48:49], v41 offset:18592
    s_waitcnt lgkmcnt(9)
    v_mfma_f32_16x16x32_bf16 v[10:13], a[60:63], a[52:55], v[10:13]
    ds_read_b64_tr_b16 a[50:51], v41 offset:20896
    v_mfma_f32_16x16x32_bf16 v[14:17], a[76:79], a[52:55], v[14:17]
    ds_read_b64_tr_b16 a[52:53], v41 offset:27808
    s_waitcnt lgkmcnt(9)
    v_mfma_f32_16x16x32_bf16 v[10:13], a[64:67], a[32:35], v[10:13]
    ds_read_b64_tr_b16 a[54:55], v41 offset:30112
    v_cvt_pk_bf16_f32 v100, v2, v3
    v_mfma_f32_16x16x32_bf16 v[14:17], a[80:83], a[32:35], v[14:17]
    ds_read_b64_tr_b16 a[32:33], v41 offset:192
    v_cvt_pk_bf16_f32 v101, v4, v5
    s_waitcnt lgkmcnt(9)
    v_mfma_f32_16x16x32_bf16 v[10:13], a[68:71], a[36:39], v[10:13]
    ds_read_b64_tr_b16 a[34:35], v41 offset:2496
    v_cvt_pk_bf16_f32 v102, v6, v7
    v_mfma_f32_16x16x32_bf16 v[14:17], a[84:87], a[36:39], v[14:17]
    ds_read_b64_tr_b16 a[36:37], v41 offset:9408
    v_cvt_pk_bf16_f32 v103, v8, v9
    s_barrier
    s_waitcnt lgkmcnt(9)
    v_mfma_f32_16x16x32_bf16 v[2:5], a[56:59], a[40:43], 0
    ds_read_b64_tr_b16 a[38:39], v41 offset:11712
    v_mfma_f32_16x16x32_bf16 v[6:9], a[72:75], a[40:43], 0
    ds_read_b64_tr_b16 a[40:41], v41 offset:18624
    s_waitcnt lgkmcnt(9)
    v_mfma_f32_16x16x32_bf16 v[2:5], a[60:63], a[44:47], v[2:5]
    ds_read_b64_tr_b16 a[42:43], v41 offset:20928
    v_mfma_f32_16x16x32_bf16 v[6:9], a[76:79], a[44:47], v[6:9]
    ds_read_b64_tr_b16 a[44:45], v41 offset:27840
    s_waitcnt lgkmcnt(9)
    v_mfma_f32_16x16x32_bf16 v[2:5], a[64:67], a[48:51], v[2:5]
    ds_read_b64_tr_b16 a[46:47], v41 offset:30144
    v_cvt_pk_bf16_f32 v112, v10, v11
    v_mfma_f32_16x16x32_bf16 v[6:9], a[80:83], a[48:51], v[6:9]
    ds_read_b64_tr_b16 a[48:49], v41 offset:224
    v_cvt_pk_bf16_f32 v113, v12, v13
    s_waitcnt lgkmcnt(9)
    v_mfma_f32_16x16x32_bf16 v[2:5], a[68:71], a[52:55], v[2:5]
    ds_read_b64_tr_b16 a[50:51], v41 offset:2528
    v_cvt_pk_bf16_f32 v114, v14, v15
    v_mfma_f32_16x16x32_bf16 v[6:9], a[84:87], a[52:55], v[6:9]
    ds_read_b64_tr_b16 a[52:53], v41 offset:9440
    v_cvt_pk_bf16_f32 v115, v16, v17
    s_waitcnt lgkmcnt(9)
    v_mfma_f32_16x16x32_bf16 v[10:13], a[56:59], a[32:35], 0
    ds_read_b64_tr_b16 a[54:55], v41 offset:11744
    v_mfma_f32_16x16x32_bf16 v[14:17], a[72:75], a[32:35], 0
    ds_read_b64_tr_b16 a[32:33], v41 offset:18656
    s_waitcnt lgkmcnt(9)
    v_mfma_f32_16x16x32_bf16 v[10:13], a[60:63], a[36:39], v[10:13]
    ds_read_b64_tr_b16 a[34:35], v41 offset:20960
    v_mfma_f32_16x16x32_bf16 v[14:17], a[76:79], a[36:39], v[14:17]
    ds_read_b64_tr_b16 a[36:37], v41 offset:27872
    s_waitcnt lgkmcnt(9)
    v_mfma_f32_16x16x32_bf16 v[10:13], a[64:67], a[40:43], v[10:13]
    ds_read_b64_tr_b16 a[38:39], v41 offset:30176
    v_cvt_pk_bf16_f32 v124, v2, v3
    v_mfma_f32_16x16x32_bf16 v[14:17], a[80:83], a[40:43], v[14:17]
    ds_read_b64_tr_b16 a[40:41], v41 offset:256
    v_cvt_pk_bf16_f32 v125, v4, v5
    s_waitcnt lgkmcnt(9)
    v_mfma_f32_16x16x32_bf16 v[10:13], a[68:71], a[44:47], v[10:13]
    ds_read_b64_tr_b16 a[42:43], v41 offset:2560
    v_cvt_pk_bf16_f32 v126, v6, v7
    v_mfma_f32_16x16x32_bf16 v[14:17], a[84:87], a[44:47], v[14:17]
    ds_read_b64_tr_b16 a[44:45], v41 offset:9472
    v_cvt_pk_bf16_f32 v127, v8, v9
    s_waitcnt lgkmcnt(9)
    v_mfma_f32_16x16x32_bf16 v[2:5], a[56:59], a[48:51], 0
    ds_read_b64_tr_b16 a[46:47], v41 offset:11776
    v_mfma_f32_16x16x32_bf16 v[6:9], a[72:75], a[48:51], 0
    ds_read_b64_tr_b16 a[48:49], v41 offset:18688
    s_waitcnt lgkmcnt(9)
    v_mfma_f32_16x16x32_bf16 v[2:5], a[60:63], a[52:55], v[2:5]
    ds_read_b64_tr_b16 a[50:51], v41 offset:20992
    v_mfma_f32_16x16x32_bf16 v[6:9], a[76:79], a[52:55], v[6:9]
    ds_read_b64_tr_b16 a[52:53], v41 offset:27904
    s_waitcnt lgkmcnt(9)
    v_mfma_f32_16x16x32_bf16 v[2:5], a[64:67], a[32:35], v[2:5]
    ds_read_b64_tr_b16 a[54:55], v41 offset:30208
    v_cvt_pk_bf16_f32 v136, v10, v11
    v_mfma_f32_16x16x32_bf16 v[6:9], a[80:83], a[32:35], v[6:9]
    v_cvt_pk_bf16_f32 v137, v12, v13
    s_waitcnt lgkmcnt(8)
    v_mfma_f32_16x16x32_bf16 v[2:5], a[68:71], a[36:39], v[2:5]
    v_cvt_pk_bf16_f32 v138, v14, v15
    v_mfma_f32_16x16x32_bf16 v[6:9], a[84:87], a[36:39], v[6:9]
    v_cvt_pk_bf16_f32 v139, v16, v17
    s_waitcnt lgkmcnt(6)
    v_mfma_f32_16x16x32_bf16 v[10:13], a[56:59], a[40:43], 0
    v_mfma_f32_16x16x32_bf16 v[14:17], a[72:75], a[40:43], 0
    s_waitcnt lgkmcnt(0)
    s_barrier
    ds_read_b128 a[56:59], v36 offset:0
    ds_read_b128 a[72:75], v36 offset:4096
    ds_read_b64_tr_b16 a[32:33], v40 offset:0
    ds_read_b64_tr_b16 a[34:35], v40 offset:2304
    ds_read_b64_tr_b16 a[36:37], v40 offset:9216
    ds_read_b64_tr_b16 a[38:39], v40 offset:11520
    v_mfma_f32_16x16x32_bf16 v[10:13], a[60:63], a[44:47], v[10:13]
    ds_read_b64_tr_b16 a[40:41], v40 offset:18432
    ds_read_b64_tr_b16 a[42:43], v40 offset:20736
    v_mfma_f32_16x16x32_bf16 v[14:17], a[76:79], a[44:47], v[14:17]
    ds_read_b128 a[60:63], v37 offset:0
    ds_read_b128 a[76:79], v37 offset:4096
    v_mfma_f32_16x16x32_bf16 v[10:13], a[64:67], a[48:51], v[10:13]
    ds_read_b64_tr_b16 a[44:45], v40 offset:27648
    ds_read_b64_tr_b16 a[46:47], v40 offset:29952
    v_cvt_pk_bf16_f32 v148, v2, v3
    v_mfma_f32_16x16x32_bf16 v[14:17], a[80:83], a[48:51], v[14:17]
    ds_read_b128 a[64:67], v38 offset:0
    ds_read_b128 a[80:83], v38 offset:4096
    v_cvt_pk_bf16_f32 v149, v4, v5
    v_mfma_f32_16x16x32_bf16 v[10:13], a[68:71], a[52:55], v[10:13]
    ds_read_b64_tr_b16 a[48:49], v40 offset:32
    ds_read_b64_tr_b16 a[50:51], v40 offset:2336
    v_cvt_pk_bf16_f32 v150, v6, v7
    v_mfma_f32_16x16x32_bf16 v[14:17], a[84:87], a[52:55], v[14:17]
    ds_read_b128 a[68:71], v39 offset:0
    ds_read_b128 a[84:87], v39 offset:4096
    v_cvt_pk_bf16_f32 v151, v8, v9
    s_waitcnt lgkmcnt(14)
    v_mfma_f32_16x16x32_bf16 v[2:5], a[56:59], a[32:35], 0
    ds_read_b64_tr_b16 a[52:53], v40 offset:9248
    ds_read_b64_tr_b16 a[54:55], v40 offset:11552
    v_mfma_f32_16x16x32_bf16 v[6:9], a[72:75], a[32:35], 0
    ds_read_b64_tr_b16 a[32:33], v40 offset:18464
    ds_read_b64_tr_b16 a[34:35], v40 offset:20768
    s_waitcnt lgkmcnt(12)
    v_mfma_f32_16x16x32_bf16 v[2:5], a[60:63], a[36:39], v[2:5]
    v_mfma_f32_16x16x32_bf16 v[6:9], a[76:79], a[36:39], v[6:9]
    ds_read_b64_tr_b16 a[36:37], v40 offset:27680
    ds_read_b64_tr_b16 a[38:39], v40 offset:29984
    s_waitcnt lgkmcnt(10)
    v_mfma_f32_16x16x32_bf16 v[2:5], a[64:67], a[40:43], v[2:5]
    v_cvt_pk_bf16_f32 v160, v10, v11
    v_mfma_f32_16x16x32_bf16 v[6:9], a[80:83], a[40:43], v[6:9]
    ds_read_b64_tr_b16 a[40:41], v40 offset:64
    ds_read_b64_tr_b16 a[42:43], v40 offset:2368
    v_cvt_pk_bf16_f32 v161, v12, v13
    s_waitcnt lgkmcnt(8)
    v_mfma_f32_16x16x32_bf16 v[2:5], a[68:71], a[44:47], v[2:5]
    v_cvt_pk_bf16_f32 v162, v14, v15
    v_mfma_f32_16x16x32_bf16 v[6:9], a[84:87], a[44:47], v[6:9]
    ds_read_b64_tr_b16 a[44:45], v40 offset:9280
    ds_read_b64_tr_b16 a[46:47], v40 offset:11584
    v_cvt_pk_bf16_f32 v163, v16, v17
    v_mfma_f32_16x16x32_bf16 v[10:13], a[56:59], a[48:51], 0
    v_mfma_f32_16x16x32_bf16 v[14:17], a[72:75], a[48:51], 0
    ds_read_b64_tr_b16 a[48:49], v40 offset:18496
    s_waitcnt lgkmcnt(9)
    v_mfma_f32_16x16x32_bf16 v[10:13], a[60:63], a[52:55], v[10:13]
    ds_read_b64_tr_b16 a[50:51], v40 offset:20800
    v_mfma_f32_16x16x32_bf16 v[14:17], a[76:79], a[52:55], v[14:17]
    ds_read_b64_tr_b16 a[52:53], v40 offset:27712
    s_waitcnt lgkmcnt(9)
    v_mfma_f32_16x16x32_bf16 v[10:13], a[64:67], a[32:35], v[10:13]
    ds_read_b64_tr_b16 a[54:55], v40 offset:30016
    v_cvt_pk_bf16_f32 v68, v2, v3
    v_mfma_f32_16x16x32_bf16 v[14:17], a[80:83], a[32:35], v[14:17]
    ds_read_b64_tr_b16 a[32:33], v40 offset:96
    v_cvt_pk_bf16_f32 v69, v4, v5
    s_waitcnt lgkmcnt(9)
    v_mfma_f32_16x16x32_bf16 v[10:13], a[68:71], a[36:39], v[10:13]
    ds_read_b64_tr_b16 a[34:35], v40 offset:2400
    v_cvt_pk_bf16_f32 v70, v6, v7
    v_mfma_f32_16x16x32_bf16 v[14:17], a[84:87], a[36:39], v[14:17]
    ds_read_b64_tr_b16 a[36:37], v40 offset:9312
    v_cvt_pk_bf16_f32 v71, v8, v9
    s_waitcnt lgkmcnt(9)
    v_mfma_f32_16x16x32_bf16 v[2:5], a[56:59], a[40:43], 0
    ds_read_b64_tr_b16 a[38:39], v40 offset:11616
    v_mfma_f32_16x16x32_bf16 v[6:9], a[72:75], a[40:43], 0
    ds_read_b64_tr_b16 a[40:41], v40 offset:18528
    s_waitcnt lgkmcnt(9)
    v_mfma_f32_16x16x32_bf16 v[2:5], a[60:63], a[44:47], v[2:5]
    ds_read_b64_tr_b16 a[42:43], v40 offset:20832
    v_mfma_f32_16x16x32_bf16 v[6:9], a[76:79], a[44:47], v[6:9]
    ds_read_b64_tr_b16 a[44:45], v40 offset:27744
    s_waitcnt lgkmcnt(9)
    v_mfma_f32_16x16x32_bf16 v[2:5], a[64:67], a[48:51], v[2:5]
    ds_read_b64_tr_b16 a[46:47], v40 offset:30048
    v_cvt_pk_bf16_f32 v80, v10, v11
    v_mfma_f32_16x16x32_bf16 v[6:9], a[80:83], a[48:51], v[6:9]
    ds_read_b64_tr_b16 a[48:49], v40 offset:128
    v_cvt_pk_bf16_f32 v81, v12, v13
    s_waitcnt lgkmcnt(9)
    v_mfma_f32_16x16x32_bf16 v[2:5], a[68:71], a[52:55], v[2:5]
    ds_read_b64_tr_b16 a[50:51], v40 offset:2432
    v_cvt_pk_bf16_f32 v82, v14, v15
    v_mfma_f32_16x16x32_bf16 v[6:9], a[84:87], a[52:55], v[6:9]
    ds_read_b64_tr_b16 a[52:53], v40 offset:9344
    v_cvt_pk_bf16_f32 v83, v16, v17
    s_waitcnt lgkmcnt(9)
    v_mfma_f32_16x16x32_bf16 v[10:13], a[56:59], a[32:35], 0
    ds_read_b64_tr_b16 a[54:55], v40 offset:11648
    v_mfma_f32_16x16x32_bf16 v[14:17], a[72:75], a[32:35], 0
    ds_read_b64_tr_b16 a[32:33], v40 offset:18560
    s_waitcnt lgkmcnt(9)
    v_mfma_f32_16x16x32_bf16 v[10:13], a[60:63], a[36:39], v[10:13]
    ds_read_b64_tr_b16 a[34:35], v40 offset:20864
    v_mfma_f32_16x16x32_bf16 v[14:17], a[76:79], a[36:39], v[14:17]
    ds_read_b64_tr_b16 a[36:37], v40 offset:27776
    s_waitcnt lgkmcnt(9)
    v_mfma_f32_16x16x32_bf16 v[10:13], a[64:67], a[40:43], v[10:13]
    ds_read_b64_tr_b16 a[38:39], v40 offset:30080
    v_cvt_pk_bf16_f32 v92, v2, v3
    v_mfma_f32_16x16x32_bf16 v[14:17], a[80:83], a[40:43], v[14:17]
    ds_read_b64_tr_b16 a[40:41], v40 offset:160
    v_cvt_pk_bf16_f32 v93, v4, v5
    s_waitcnt lgkmcnt(9)
    v_mfma_f32_16x16x32_bf16 v[10:13], a[68:71], a[44:47], v[10:13]
    ds_read_b64_tr_b16 a[42:43], v40 offset:2464
    v_cvt_pk_bf16_f32 v94, v6, v7
    v_mfma_f32_16x16x32_bf16 v[14:17], a[84:87], a[44:47], v[14:17]
    ds_read_b64_tr_b16 a[44:45], v40 offset:9376
    v_cvt_pk_bf16_f32 v95, v8, v9
    s_waitcnt lgkmcnt(9)
    v_mfma_f32_16x16x32_bf16 v[2:5], a[56:59], a[48:51], 0
    ds_read_b64_tr_b16 a[46:47], v40 offset:11680
    v_mfma_f32_16x16x32_bf16 v[6:9], a[72:75], a[48:51], 0
    ds_read_b64_tr_b16 a[48:49], v40 offset:18592
    s_waitcnt lgkmcnt(9)
    v_mfma_f32_16x16x32_bf16 v[2:5], a[60:63], a[52:55], v[2:5]
    ds_read_b64_tr_b16 a[50:51], v40 offset:20896
    v_mfma_f32_16x16x32_bf16 v[6:9], a[76:79], a[52:55], v[6:9]
    ds_read_b64_tr_b16 a[52:53], v40 offset:27808
    s_waitcnt lgkmcnt(9)
    v_mfma_f32_16x16x32_bf16 v[2:5], a[64:67], a[32:35], v[2:5]
    ds_read_b64_tr_b16 a[54:55], v40 offset:30112
    v_cvt_pk_bf16_f32 v104, v10, v11
    v_mfma_f32_16x16x32_bf16 v[6:9], a[80:83], a[32:35], v[6:9]
    ds_read_b64_tr_b16 a[32:33], v40 offset:192
    v_cvt_pk_bf16_f32 v105, v12, v13
    s_waitcnt lgkmcnt(9)
    v_mfma_f32_16x16x32_bf16 v[2:5], a[68:71], a[36:39], v[2:5]
    ds_read_b64_tr_b16 a[34:35], v40 offset:2496
    v_cvt_pk_bf16_f32 v106, v14, v15
    v_mfma_f32_16x16x32_bf16 v[6:9], a[84:87], a[36:39], v[6:9]
    ds_read_b64_tr_b16 a[36:37], v40 offset:9408
    v_cvt_pk_bf16_f32 v107, v16, v17
    s_barrier
    s_waitcnt lgkmcnt(9)
    v_mfma_f32_16x16x32_bf16 v[10:13], a[56:59], a[40:43], 0
    ds_read_b64_tr_b16 a[38:39], v40 offset:11712
    v_mfma_f32_16x16x32_bf16 v[14:17], a[72:75], a[40:43], 0
    ds_read_b64_tr_b16 a[40:41], v40 offset:18624
    s_waitcnt lgkmcnt(9)
    v_mfma_f32_16x16x32_bf16 v[10:13], a[60:63], a[44:47], v[10:13]
    ds_read_b64_tr_b16 a[42:43], v40 offset:20928
    v_mfma_f32_16x16x32_bf16 v[14:17], a[76:79], a[44:47], v[14:17]
    ds_read_b64_tr_b16 a[44:45], v40 offset:27840
    s_waitcnt lgkmcnt(9)
    v_mfma_f32_16x16x32_bf16 v[10:13], a[64:67], a[48:51], v[10:13]
    ds_read_b64_tr_b16 a[46:47], v40 offset:30144
    v_cvt_pk_bf16_f32 v116, v2, v3
    v_mfma_f32_16x16x32_bf16 v[14:17], a[80:83], a[48:51], v[14:17]
    ds_read_b64_tr_b16 a[48:49], v40 offset:224
    v_cvt_pk_bf16_f32 v117, v4, v5
    s_waitcnt lgkmcnt(9)
    v_mfma_f32_16x16x32_bf16 v[10:13], a[68:71], a[52:55], v[10:13]
    ds_read_b64_tr_b16 a[50:51], v40 offset:2528
    v_cvt_pk_bf16_f32 v118, v6, v7
    v_mfma_f32_16x16x32_bf16 v[14:17], a[84:87], a[52:55], v[14:17]
    ds_read_b64_tr_b16 a[52:53], v40 offset:9440
    v_cvt_pk_bf16_f32 v119, v8, v9
    s_waitcnt lgkmcnt(9)
    v_mfma_f32_16x16x32_bf16 v[2:5], a[56:59], a[32:35], 0
    ds_read_b64_tr_b16 a[54:55], v40 offset:11744
    v_mfma_f32_16x16x32_bf16 v[6:9], a[72:75], a[32:35], 0
    ds_read_b64_tr_b16 a[32:33], v40 offset:18656
    s_waitcnt lgkmcnt(9)
    v_mfma_f32_16x16x32_bf16 v[2:5], a[60:63], a[36:39], v[2:5]
    ds_read_b64_tr_b16 a[34:35], v40 offset:20960
    v_mfma_f32_16x16x32_bf16 v[6:9], a[76:79], a[36:39], v[6:9]
    ds_read_b64_tr_b16 a[36:37], v40 offset:27872
    s_waitcnt lgkmcnt(9)
    v_mfma_f32_16x16x32_bf16 v[2:5], a[64:67], a[40:43], v[2:5]
    ds_read_b64_tr_b16 a[38:39], v40 offset:30176
    v_cvt_pk_bf16_f32 v128, v10, v11
    v_mfma_f32_16x16x32_bf16 v[6:9], a[80:83], a[40:43], v[6:9]
    ds_read_b64_tr_b16 a[40:41], v40 offset:256
    v_cvt_pk_bf16_f32 v129, v12, v13
    s_waitcnt lgkmcnt(9)
    v_mfma_f32_16x16x32_bf16 v[2:5], a[68:71], a[44:47], v[2:5]
    ds_read_b64_tr_b16 a[42:43], v40 offset:2560
    v_cvt_pk_bf16_f32 v130, v14, v15
    v_mfma_f32_16x16x32_bf16 v[6:9], a[84:87], a[44:47], v[6:9]
    ds_read_b64_tr_b16 a[44:45], v40 offset:9472
    v_cvt_pk_bf16_f32 v131, v16, v17
    s_waitcnt lgkmcnt(9)
    v_mfma_f32_16x16x32_bf16 v[10:13], a[56:59], a[48:51], 0
    ds_read_b64_tr_b16 a[46:47], v40 offset:11776
    v_mfma_f32_16x16x32_bf16 v[14:17], a[72:75], a[48:51], 0
    ds_read_b64_tr_b16 a[48:49], v40 offset:18688
    s_waitcnt lgkmcnt(9)
    v_mfma_f32_16x16x32_bf16 v[10:13], a[60:63], a[52:55], v[10:13]
    ds_read_b64_tr_b16 a[50:51], v40 offset:20992
    v_mfma_f32_16x16x32_bf16 v[14:17], a[76:79], a[52:55], v[14:17]
    ds_read_b64_tr_b16 a[52:53], v40 offset:27904
    s_waitcnt lgkmcnt(9)
    v_mfma_f32_16x16x32_bf16 v[10:13], a[64:67], a[32:35], v[10:13]
    ds_read_b64_tr_b16 a[54:55], v40 offset:30208
    v_cvt_pk_bf16_f32 v140, v2, v3
    v_mfma_f32_16x16x32_bf16 v[14:17], a[80:83], a[32:35], v[14:17]
    v_cvt_pk_bf16_f32 v141, v4, v5
    s_waitcnt lgkmcnt(8)
    v_mfma_f32_16x16x32_bf16 v[10:13], a[68:71], a[36:39], v[10:13]
    v_cvt_pk_bf16_f32 v142, v6, v7
    v_mfma_f32_16x16x32_bf16 v[14:17], a[84:87], a[36:39], v[14:17]
    v_cvt_pk_bf16_f32 v143, v8, v9
    s_waitcnt lgkmcnt(6)
    v_mfma_f32_16x16x32_bf16 v[2:5], a[56:59], a[40:43], 0
    v_mfma_f32_16x16x32_bf16 v[6:9], a[72:75], a[40:43], 0
    s_waitcnt lgkmcnt(0)
    s_barrier
    v_add_u32 v31, 4294893568, v36
    ds_read_b128 a[56:59], v31 offset:0
    ds_read_b128 a[72:75], v31 offset:4096
    ds_read_b64_tr_b16 a[32:33], v41 offset:0
    ds_read_b64_tr_b16 a[34:35], v41 offset:2304
    ds_read_b64_tr_b16 a[36:37], v41 offset:9216
    ds_read_b64_tr_b16 a[38:39], v41 offset:11520
    v_mfma_f32_16x16x32_bf16 v[2:5], a[60:63], a[44:47], v[2:5]
    ds_read_b64_tr_b16 a[40:41], v41 offset:18432
    ds_read_b64_tr_b16 a[42:43], v41 offset:20736
    v_mfma_f32_16x16x32_bf16 v[6:9], a[76:79], a[44:47], v[6:9]
    v_add_u32 v31, 4294893568, v37
    ds_read_b128 a[60:63], v31 offset:0
    ds_read_b128 a[76:79], v31 offset:4096
    v_mfma_f32_16x16x32_bf16 v[2:5], a[64:67], a[48:51], v[2:5]
    ds_read_b64_tr_b16 a[44:45], v41 offset:27648
    ds_read_b64_tr_b16 a[46:47], v41 offset:29952
    v_cvt_pk_bf16_f32 v152, v10, v11
    v_mfma_f32_16x16x32_bf16 v[6:9], a[80:83], a[48:51], v[6:9]
    v_add_u32 v31, 4294893568, v38
    ds_read_b128 a[64:67], v31 offset:0
    ds_read_b128 a[80:83], v31 offset:4096
    v_cvt_pk_bf16_f32 v153, v12, v13
    v_mfma_f32_16x16x32_bf16 v[2:5], a[68:71], a[52:55], v[2:5]
    ds_read_b64_tr_b16 a[48:49], v41 offset:32
    ds_read_b64_tr_b16 a[50:51], v41 offset:2336
    v_cvt_pk_bf16_f32 v154, v14, v15
    v_mfma_f32_16x16x32_bf16 v[6:9], a[84:87], a[52:55], v[6:9]
    v_add_u32 v31, 4294893568, v39
    ds_read_b128 a[68:71], v31 offset:0
    ds_read_b128 a[84:87], v31 offset:4096
    v_cvt_pk_bf16_f32 v155, v16, v17
    s_waitcnt lgkmcnt(14)
    v_mfma_f32_16x16x32_bf16 v[10:13], a[56:59], a[32:35], 0
    ds_read_b64_tr_b16 a[52:53], v41 offset:9248
    ds_read_b64_tr_b16 a[54:55], v41 offset:11552
    v_mfma_f32_16x16x32_bf16 v[14:17], a[72:75], a[32:35], 0
    ds_read_b64_tr_b16 a[32:33], v41 offset:18464
    ds_read_b64_tr_b16 a[34:35], v41 offset:20768
    s_add_u32 s71, s83, 73728
    s_cmp_eq_u32 s101, 0
    s_cselect_b32 s71, s76, s71
    v_add_u32 v33, s71, v42
    ds_read_b128 a[0:3], v33 offset:0
    ds_read_b128 a[4:7], v33 offset:1024
    s_waitcnt lgkmcnt(14)
    v_mfma_f32_16x16x32_bf16 v[10:13], a[60:63], a[36:39], v[10:13]
    v_mfma_f32_16x16x32_bf16 v[14:17], a[76:79], a[36:39], v[14:17]
    ds_read_b64_tr_b16 a[36:37], v41 offset:27680
    ds_read_b64_tr_b16 a[38:39], v41 offset:29984
    s_add_u32 s71, s83, 75776
    s_cmp_eq_u32 s101, 1
    s_cselect_b32 s71, s76, s71
    v_add_u32 v33, s71, v42
    ds_read_b128 a[8:11], v33 offset:0
    ds_read_b128 a[12:15], v33 offset:1024
    s_waitcnt lgkmcnt(14)
    v_mfma_f32_16x16x32_bf16 v[10:13], a[64:67], a[40:43], v[10:13]
    v_cvt_pk_bf16_f32 v164, v2, v3
    v_mfma_f32_16x16x32_bf16 v[14:17], a[80:83], a[40:43], v[14:17]
    ds_read_b64_tr_b16 a[40:41], v41 offset:64
    ds_read_b64_tr_b16 a[42:43], v41 offset:2368
    v_cvt_pk_bf16_f32 v165, v4, v5
    s_add_u32 s71, s83, 77824
    s_cmp_eq_u32 s101, 2
    s_cselect_b32 s71, s76, s71
    v_add_u32 v33, s71, v42
    ds_read_b128 a[16:19], v33 offset:0
    ds_read_b128 a[20:23], v33 offset:1024
    s_waitcnt lgkmcnt(14)
    v_mfma_f32_16x16x32_bf16 v[10:13], a[68:71], a[44:47], v[10:13]
    v_cvt_pk_bf16_f32 v166, v6, v7
    v_mfma_f32_16x16x32_bf16 v[14:17], a[84:87], a[44:47], v[14:17]
    ds_read_b64_tr_b16 a[44:45], v41 offset:9280
    ds_read_b64_tr_b16 a[46:47], v41 offset:11584
    v_cvt_pk_bf16_f32 v167, v8, v9
    s_add_u32 s71, s83, 79872
    s_cmp_eq_u32 s101, 3
    s_cselect_b32 s71, s76, s71
    v_add_u32 v33, s71, v42
    ds_read_b128 a[24:27], v33 offset:0
    ds_read_b128 a[28:31], v33 offset:1024
    v_mfma_f32_16x16x32_bf16 v[2:5], a[56:59], a[48:51], 0
    v_mfma_f32_16x16x32_bf16 v[6:9], a[72:75], a[48:51], 0
    ds_read_b64_tr_b16 a[48:49], v41 offset:18496
    s_cmp_eq_u32 s54, 0
    s_cselect_b64 vcc, -1, 0
    s_cmp_eq_u32 s54, 1
    s_waitcnt lgkmcnt(13)
    v_mfma_f32_16x16x32_bf16 v[48:51], v[60:63], a[0:3], 0
    v_mfma_f32_16x16x32_bf16 v[52:55], v[60:63], a[4:7], 0
    v_cvt_pk_bf16_f32 v18, v10, v11
    v_cvt_pk_bf16_f32 v19, v12, v13
    v_mfma_f32_16x16x32_bf16 v[2:5], a[60:63], a[52:55], v[2:5]
    ds_read_b64_tr_b16 a[50:51], v41 offset:20800
    v_mfma_f32_16x16x32_bf16 v[6:9], a[76:79], a[52:55], v[6:9]
    ds_read_b64_tr_b16 a[52:53], v41 offset:27712
    s_waitcnt lgkmcnt(11)
    v_mfma_f32_16x16x32_bf16 v[48:51], v[64:67], a[8:11], v[48:51]
    v_cvt_pk_bf16_f32 v20, v14, v15
    v_cvt_pk_bf16_f32 v21, v16, v17
    v_mfma_f32_16x16x32_bf16 v[52:55], v[64:67], a[12:15], v[52:55]
    v_mfma_f32_16x16x32_bf16 v[2:5], a[64:67], a[32:35], v[2:5]
    ds_read_b64_tr_b16 a[54:55], v41 offset:30016
    v_mfma_f32_16x16x32_bf16 v[6:9], a[80:83], a[32:35], v[6:9]
    ds_read_b64_tr_b16 a[32:33], v41 offset:96
    s_waitcnt lgkmcnt(9)
    v_mfma_f32_16x16x32_bf16 v[48:51], v[68:71], a[16:19], v[48:51]
    v_mfma_f32_16x16x32_bf16 v[52:55], v[68:71], a[20:23], v[52:55]
    v_mfma_f32_16x16x32_bf16 v[2:5], a[68:71], a[36:39], v[2:5]
    ds_read_b64_tr_b16 a[34:35], v41 offset:2400
    v_mfma_f32_16x16x32_bf16 v[6:9], a[84:87], a[36:39], v[6:9]
    ds_read_b64_tr_b16 a[36:37], v41 offset:9312
    s_waitcnt lgkmcnt(7)
    v_mfma_f32_16x16x32_bf16 v[48:51], v[18:21], a[24:27], v[48:51]
    v_mfma_f32_16x16x32_bf16 v[52:55], v[18:21], a[28:31], v[52:55]
    v_mfma_f32_16x16x32_bf16 v[10:13], a[56:59], a[40:43], 0
    ds_read_b64_tr_b16 a[38:39], v41 offset:11616
    v_mfma_f32_16x16x32_bf16 v[14:17], a[72:75], a[40:43], 0
    ds_read_b64_tr_b16 a[40:41], v41 offset:18528
    v_mfma_f32_16x16x32_bf16 v[60:63], v[72:75], a[0:3], 0
    v_mfma_f32_16x16x32_bf16 v[64:67], v[72:75], a[4:7], 0
    v_cvt_pk_bf16_f32 v22, v2, v3
    v_cvt_pk_bf16_f32 v23, v4, v5
    v_mfma_f32_16x16x32_bf16 v[10:13], a[60:63], a[44:47], v[10:13]
    ds_read_b64_tr_b16 a[42:43], v41 offset:20832
    v_mfma_f32_16x16x32_bf16 v[14:17], a[76:79], a[44:47], v[14:17]
    ds_read_b64_tr_b16 a[44:45], v41 offset:27744
    v_mfma_f32_16x16x32_bf16 v[60:63], v[76:79], a[8:11], v[60:63]
    v_cvt_pk_bf16_f32 v24, v6, v7
    v_cvt_pk_bf16_f32 v25, v8, v9
    v_mfma_f32_16x16x32_bf16 v[64:67], v[76:79], a[12:15], v[64:67]
    s_waitcnt lgkmcnt(9)
    v_mfma_f32_16x16x32_bf16 v[10:13], a[64:67], a[48:51], v[10:13]
    ds_read_b64_tr_b16 a[46:47], v41 offset:30048
    v_mfma_f32_16x16x32_bf16 v[14:17], a[80:83], a[48:51], v[14:17]
    ds_read_b64_tr_b16 a[48:49], v41 offset:128
    v_mfma_f32_16x16x32_bf16 v[60:63], v[80:83], a[16:19], v[60:63]
    v_mfma_f32_16x16x32_bf16 v[64:67], v[80:83], a[20:23], v[64:67]
    s_waitcnt lgkmcnt(9)
    v_mfma_f32_16x16x32_bf16 v[10:13], a[68:71], a[52:55], v[10:13]
    ds_read_b64_tr_b16 a[50:51], v41 offset:2432
    v_mfma_f32_16x16x32_bf16 v[14:17], a[84:87], a[52:55], v[14:17]
    ds_read_b64_tr_b16 a[52:53], v41 offset:9344
    v_mfma_f32_16x16x32_bf16 v[60:63], v[22:25], a[24:27], v[60:63]
    v_mfma_f32_16x16x32_bf16 v[64:67], v[22:25], a[28:31], v[64:67]
    s_waitcnt lgkmcnt(9)
    v_mfma_f32_16x16x32_bf16 v[2:5], a[56:59], a[32:35], 0
    ds_read_b64_tr_b16 a[54:55], v41 offset:11648
    v_mfma_f32_16x16x32_bf16 v[6:9], a[72:75], a[32:35], 0
    ds_read_b64_tr_b16 a[32:33], v41 offset:18560
    v_mfma_f32_16x16x32_bf16 v[72:75], v[84:87], a[0:3], 0
    v_mfma_f32_16x16x32_bf16 v[76:79], v[84:87], a[4:7], 0
    v_cvt_pk_bf16_f32 v18, v10, v11
    v_cvt_pk_bf16_f32 v19, v12, v13
    s_waitcnt lgkmcnt(9)
    v_mfma_f32_16x16x32_bf16 v[2:5], a[60:63], a[36:39], v[2:5]
    ds_read_b64_tr_b16 a[34:35], v41 offset:20864
    v_mfma_f32_16x16x32_bf16 v[6:9], a[76:79], a[36:39], v[6:9]
    ds_read_b64_tr_b16 a[36:37], v41 offset:27776
    v_mfma_f32_16x16x32_bf16 v[72:75], v[88:91], a[8:11], v[72:75]
    v_cvt_pk_bf16_f32 v20, v14, v15
    v_cvt_pk_bf16_f32 v21, v16, v17
    v_mfma_f32_16x16x32_bf16 v[76:79], v[88:91], a[12:15], v[76:79]
    v_cvt_pk_bf16_f32 v56, v48, v49
    v_cvt_pk_bf16_f32 v57, v50, v51
    s_waitcnt lgkmcnt(9)
    v_mfma_f32_16x16x32_bf16 v[2:5], a[64:67], a[40:43], v[2:5]
    ds_read_b64_tr_b16 a[38:39], v41 offset:30080
    v_mfma_f32_16x16x32_bf16 v[6:9], a[80:83], a[40:43], v[6:9]
    ds_read_b64_tr_b16 a[40:41], v41 offset:160
    v_mfma_f32_16x16x32_bf16 v[72:75], v[92:95], a[16:19], v[72:75]
    v_cvt_pk_bf16_f32 v58, v60, v61
    v_cvt_pk_bf16_f32 v59, v62, v63
    v_mfma_f32_16x16x32_bf16 v[76:79], v[92:95], a[20:23], v[76:79]
    s_cbranch_vccnz L_ow0
    buffer_store_dwordx4 v[56:59], v42, s[20:23], s49 offen offset:0 sc1
L_ox0:
    v_cvt_pk_bf16_f32 v68, v52, v53
    s_waitcnt lgkmcnt(9)
    v_mfma_f32_16x16x32_bf16 v[2:5], a[68:71], a[44:47], v[2:5]
    ds_read_b64_tr_b16 a[42:43], v41 offset:2464
    v_mfma_f32_16x16x32_bf16 v[6:9], a[84:87], a[44:47], v[6:9]
    ds_read_b64_tr_b16 a[44:45], v41 offset:9376
    v_mfma_f32_16x16x32_bf16 v[72:75], v[18:21], a[24:27], v[72:75]
    v_cvt_pk_bf16_f32 v69, v54, v55
    v_cvt_pk_bf16_f32 v70, v64, v65
    v_mfma_f32_16x16x32_bf16 v[76:79], v[18:21], a[28:31], v[76:79]
    v_cvt_pk_bf16_f32 v71, v66, v67
    s_cbranch_scc1 L_ow1
    buffer_store_dwordx4 v[68:71], v42, s[20:23], s50 offen offset:0 sc1
L_ox1:
    s_waitcnt lgkmcnt(9)
    v_mfma_f32_16x16x32_bf16 v[10:13], a[56:59], a[48:51], 0
    ds_read_b64_tr_b16 a[46:47], v41 offset:11680
    v_mfma_f32_16x16x32_bf16 v[14:17], a[72:75], a[48:51], 0
    ds_read_b64_tr_b16 a[48:49], v41 offset:18592
    v_mfma_f32_16x16x32_bf16 v[84:87], v[96:99], a[0:3], 0
    v_mfma_f32_16x16x32_bf16 v[88:91], v[96:99], a[4:7], 0
    v_cvt_pk_bf16_f32 v22, v2, v3
    v_cvt_pk_bf16_f32 v23, v4, v5
    s_waitcnt lgkmcnt(9)
    v_mfma_f32_16x16x32_bf16 v[10:13], a[60:63], a[52:55], v[10:13]
    ds_read_b64_tr_b16 a[50:51], v41 offset:20896
    v_mfma_f32_16x16x32_bf16 v[14:17], a[76:79], a[52:55], v[14:17]
    ds_read_b64_tr_b16 a[52:53], v41 offset:27808
    v_mfma_f32_16x16x32_bf16 v[84:87], v[100:103], a[8:11], v[84:87]
    v_cvt_pk_bf16_f32 v24, v6, v7
    v_cvt_pk_bf16_f32 v25, v8, v9
    v_mfma_f32_16x16x32_bf16 v[88:91], v[100:103], a[12:15], v[88:91]
    s_waitcnt lgkmcnt(9)
    v_mfma_f32_16x16x32_bf16 v[10:13], a[64:67], a[32:35], v[10:13]
    ds_read_b64_tr_b16 a[54:55], v41 offset:30112
    v_mfma_f32_16x16x32_bf16 v[14:17], a[80:83], a[32:35], v[14:17]
    ds_read_b64_tr_b16 a[32:33], v41 offset:192
    v_mfma_f32_16x16x32_bf16 v[84:87], v[104:107], a[16:19], v[84:87]
    v_mfma_f32_16x16x32_bf16 v[88:91], v[104:107], a[20:23], v[88:91]
    s_waitcnt lgkmcnt(9)
    v_mfma_f32_16x16x32_bf16 v[10:13], a[68:71], a[36:39], v[10:13]
    ds_read_b64_tr_b16 a[34:35], v41 offset:2496
    v_mfma_f32_16x16x32_bf16 v[14:17], a[84:87], a[36:39], v[14:17]
    ds_read_b64_tr_b16 a[36:37], v41 offset:9408
    v_mfma_f32_16x16x32_bf16 v[84:87], v[22:25], a[24:27], v[84:87]
    v_mfma_f32_16x16x32_bf16 v[88:91], v[22:25], a[28:31], v[88:91]
    s_waitcnt lgkmcnt(9)
    v_mfma_f32_16x16x32_bf16 v[2:5], a[56:59], a[40:43], 0
    ds_read_b64_tr_b16 a[38:39], v41 offset:11712
    v_mfma_f32_16x16x32_bf16 v[6:9], a[72:75], a[40:43], 0
    ds_read_b64_tr_b16 a[40:41], v41 offset:18624
    v_mfma_f32_16x16x32_bf16 v[96:99], v[108:111], a[0:3], 0
    v_mfma_f32_16x16x32_bf16 v[100:103], v[108:111], a[4:7], 0
    v_cvt_pk_bf16_f32 v18, v10, v11
    v_cvt_pk_bf16_f32 v19, v12, v13
    s_waitcnt lgkmcnt(9)
    v_mfma_f32_16x16x32_bf16 v[2:5], a[60:63], a[44:47], v[2:5]
    ds_read_b64_tr_b16 a[42:43], v41 offset:20928
    v_mfma_f32_16x16x32_bf16 v[6:9], a[76:79], a[44:47], v[6:9]
    ds_read_b64_tr_b16 a[44:45], v41 offset:27840
    v_mfma_f32_16x16x32_bf16 v[96:99], v[112:115], a[8:11], v[96:99]
    v_cvt_pk_bf16_f32 v20, v14, v15
    v_cvt_pk_bf16_f32 v21, v16, v17
    v_mfma_f32_16x16x32_bf16 v[100:103], v[112:115], a[12:15], v[100:103]
    v_cvt_pk_bf16_f32 v80, v72, v73
    v_cvt_pk_bf16_f32 v81, v74, v75
    s_waitcnt lgkmcnt(9)
    v_mfma_f32_16x16x32_bf16 v[2:5], a[64:67], a[48:51], v[2:5]
    ds_read_b64_tr_b16 a[46:47], v41 offset:30144
    v_mfma_f32_16x16x32_bf16 v[6:9], a[80:83], a[48:51], v[6:9]
    ds_read_b64_tr_b16 a[48:49], v41 offset:224
    v_mfma_f32_16x16x32_bf16 v[96:99], v[116:119], a[16:19], v[96:99]
    v_cvt_pk_bf16_f32 v82, v84, v85
    v_cvt_pk_bf16_f32 v83, v86, v87
    v_mfma_f32_16x16x32_bf16 v[100:103], v[116:119], a[20:23], v[100:103]
    s_cbranch_vccnz L_ow2
    buffer_store_dwordx4 v[80:83], v42, s[20:23], s49 offen offset:1024 sc1
L_ox2:
    v_cvt_pk_bf16_f32 v92, v76, v77
    s_waitcnt lgkmcnt(9)
    v_mfma_f32_16x16x32_bf16 v[2:5], a[68:71], a[52:55], v[2:5]
    ds_read_b64_tr_b16 a[50:51], v41 offset:2528
    v_mfma_f32_16x16x32_bf16 v[6:9], a[84:87], a[52:55], v[6:9]
    ds_read_b64_tr_b16 a[52:53], v41 offset:9440
    v_mfma_f32_16x16x32_bf16 v[96:99], v[18:21], a[24:27], v[96:99]
    v_cvt_pk_bf16_f32 v93, v78, v79
    v_cvt_pk_bf16_f32 v94, v88, v89
    v_mfma_f32_16x16x32_bf16 v[100:103], v[18:21], a[28:31], v[100:103]
    v_cvt_pk_bf16_f32 v95, v90, v91
    s_cbranch_scc1 L_ow3
    buffer_store_dwordx4 v[92:95], v42, s[20:23], s50 offen offset:1024 sc1
L_ox3:
    s_waitcnt lgkmcnt(9)
    v_mfma_f32_16x16x32_bf16 v[10:13], a[56:59], a[32:35], 0
    ds_read_b64_tr_b16 a[54:55], v41 offset:11744
    v_mfma_f32_16x16x32_bf16 v[14:17], a[72:75], a[32:35], 0
    ds_read_b64_tr_b16 a[32:33], v41 offset:18656
    v_mfma_f32_16x16x32_bf16 v[108:111], v[120:123], a[0:3], 0
    v_mfma_f32_16x16x32_bf16 v[112:115], v[120:123], a[4:7], 0
    v_cvt_pk_bf16_f32 v22, v2, v3
    v_cvt_pk_bf16_f32 v23, v4, v5
    s_waitcnt lgkmcnt(9)
    v_mfma_f32_16x16x32_bf16 v[10:13], a[60:63], a[36:39], v[10:13]
    ds_read_b64_tr_b16 a[34:35], v41 offset:20960
    v_mfma_f32_16x16x32_bf16 v[14:17], a[76:79], a[36:39], v[14:17]
    ds_read_b64_tr_b16 a[36:37], v41 offset:27872
    v_mfma_f32_16x16x32_bf16 v[108:111], v[124:127], a[8:11], v[108:111]
    v_cvt_pk_bf16_f32 v24, v6, v7
    v_cvt_pk_bf16_f32 v25, v8, v9
    v_mfma_f32_16x16x32_bf16 v[112:115], v[124:127], a[12:15], v[112:115]
    s_waitcnt lgkmcnt(9)
    v_mfma_f32_16x16x32_bf16 v[10:13], a[64:67], a[40:43], v[10:13]
    ds_read_b64_tr_b16 a[38:39], v41 offset:30176
    v_mfma_f32_16x16x32_bf16 v[14:17], a[80:83], a[40:43], v[14:17]
    ds_read_b64_tr_b16 a[40:41], v41 offset:256
    v_mfma_f32_16x16x32_bf16 v[108:111], v[128:131], a[16:19], v[108:111]
    v_mfma_f32_16x16x32_bf16 v[112:115], v[128:131], a[20:23], v[112:115]
    s_waitcnt lgkmcnt(9)
    v_mfma_f32_16x16x32_bf16 v[10:13], a[68:71], a[44:47], v[10:13]
    ds_read_b64_tr_b16 a[42:43], v41 offset:2560
    v_mfma_f32_16x16x32_bf16 v[14:17], a[84:87], a[44:47], v[14:17]
    ds_read_b64_tr_b16 a[44:45], v41 offset:9472
    v_mfma_f32_16x16x32_bf16 v[108:111], v[22:25], a[24:27], v[108:111]
    v_mfma_f32_16x16x32_bf16 v[112:115], v[22:25], a[28:31], v[112:115]
    s_waitcnt lgkmcnt(9)
    v_mfma_f32_16x16x32_bf16 v[2:5], a[56:59], a[48:51], 0
    ds_read_b64_tr_b16 a[46:47], v41 offset:11776
    v_mfma_f32_16x16x32_bf16 v[6:9], a[72:75], a[48:51], 0
    ds_read_b64_tr_b16 a[48:49], v41 offset:18688
    v_mfma_f32_16x16x32_bf16 v[120:123], v[132:135], a[0:3], 0
    v_mfma_f32_16x16x32_bf16 v[124:127], v[132:135], a[4:7], 0
    v_cvt_pk_bf16_f32 v18, v10, v11
    v_cvt_pk_bf16_f32 v19, v12, v13
    s_waitcnt lgkmcnt(9)
    v_mfma_f32_16x16x32_bf16 v[2:5], a[60:63], a[52:55], v[2:5]
    ds_read_b64_tr_b16 a[50:51], v41 offset:20992
    v_mfma_f32_16x16x32_bf16 v[6:9], a[76:79], a[52:55], v[6:9]
    ds_read_b64_tr_b16 a[52:53], v41 offset:27904
    v_mfma_f32_16x16x32_bf16 v[120:123], v[136:139], a[8:11], v[120:123]
    v_cvt_pk_bf16_f32 v20, v14, v15
    v_cvt_pk_bf16_f32 v21, v16, v17
    v_mfma_f32_16x16x32_bf16 v[124:127], v[136:139], a[12:15], v[124:127]
    v_cvt_pk_bf16_f32 v104, v96, v97
    v_cvt_pk_bf16_f32 v105, v98, v99
    s_waitcnt lgkmcnt(9)
    v_mfma_f32_16x16x32_bf16 v[2:5], a[64:67], a[32:35], v[2:5]
    ds_read_b64_tr_b16 a[54:55], v41 offset:30208
    v_mfma_f32_16x16x32_bf16 v[6:9], a[80:83], a[32:35], v[6:9]
    v_mfma_f32_16x16x32_bf16 v[120:123], v[140:143], a[16:19], v[120:123]
    v_cvt_pk_bf16_f32 v106, v108, v109
    v_cvt_pk_bf16_f32 v107, v110, v111
    v_mfma_f32_16x16x32_bf16 v[124:127], v[140:143], a[20:23], v[124:127]
    s_cbranch_vccnz L_ow4
    buffer_store_dwordx4 v[104:107], v42, s[20:23], s49 offen offset:2048 sc1
L_ox4:
    v_cvt_pk_bf16_f32 v116, v100, v101
    s_waitcnt lgkmcnt(8)
    v_mfma_f32_16x16x32_bf16 v[2:5], a[68:71], a[36:39], v[2:5]
    v_mfma_f32_16x16x32_bf16 v[6:9], a[84:87], a[36:39], v[6:9]
    v_mfma_f32_16x16x32_bf16 v[120:123], v[18:21], a[24:27], v[120:123]
    v_cvt_pk_bf16_f32 v117, v102, v103
    v_cvt_pk_bf16_f32 v118, v112, v113
    v_mfma_f32_16x16x32_bf16 v[124:127], v[18:21], a[28:31], v[124:127]
    v_cvt_pk_bf16_f32 v119, v114, v115
    s_cbranch_scc1 L_ow5
    buffer_store_dwordx4 v[116:119], v42, s[20:23], s50 offen offset:2048 sc1
L_ox5:
    s_waitcnt lgkmcnt(6)
    v_mfma_f32_16x16x32_bf16 v[10:13], a[56:59], a[40:43], 0
    v_mfma_f32_16x16x32_bf16 v[14:17], a[72:75], a[40:43], 0
    v_mfma_f32_16x16x32_bf16 v[132:135], v[144:147], a[0:3], 0
    v_mfma_f32_16x16x32_bf16 v[136:139], v[144:147], a[4:7], 0
    v_cvt_pk_bf16_f32 v22, v2, v3
    v_cvt_pk_bf16_f32 v23, v4, v5
    s_waitcnt lgkmcnt(4)
    v_mfma_f32_16x16x32_bf16 v[10:13], a[60:63], a[44:47], v[10:13]
    v_mfma_f32_16x16x32_bf16 v[14:17], a[76:79], a[44:47], v[14:17]
    v_mfma_f32_16x16x32_bf16 v[132:135], v[148:151], a[8:11], v[132:135]
    v_cvt_pk_bf16_f32 v24, v6, v7
    v_cvt_pk_bf16_f32 v25, v8, v9
    v_mfma_f32_16x16x32_bf16 v[136:139], v[148:151], a[12:15], v[136:139]
    s_waitcnt lgkmcnt(2)
    v_mfma_f32_16x16x32_bf16 v[10:13], a[64:67], a[48:51], v[10:13]
    v_mfma_f32_16x16x32_bf16 v[14:17], a[80:83], a[48:51], v[14:17]
    v_mfma_f32_16x16x32_bf16 v[132:135], v[152:155], a[16:19], v[132:135]
    v_mfma_f32_16x16x32_bf16 v[136:139], v[152:155], a[20:23], v[136:139]
    s_waitcnt lgkmcnt(0)
    v_mfma_f32_16x16x32_bf16 v[10:13], a[68:71], a[52:55], v[10:13]
    v_mfma_f32_16x16x32_bf16 v[14:17], a[84:87], a[52:55], v[14:17]
    v_mfma_f32_16x16x32_bf16 v[132:135], v[22:25], a[24:27], v[132:135]
    v_mfma_f32_16x16x32_bf16 v[136:139], v[22:25], a[28:31], v[136:139]
    v_mfma_f32_16x16x32_bf16 v[144:147], v[156:159], a[0:3], 0
    v_mfma_f32_16x16x32_bf16 v[148:151], v[156:159], a[4:7], 0
    v_mfma_f32_16x16x32_bf16 v[144:147], v[160:163], a[8:11], v[144:147]
    v_mfma_f32_16x16x32_bf16 v[148:151], v[160:163], a[12:15], v[148:151]
    v_mfma_f32_16x16x32_bf16 v[144:147], v[164:167], a[16:19], v[144:147]
    v_cvt_pk_bf16_f32 v18, v10, v11
    v_cvt_pk_bf16_f32 v19, v12, v13
    v_mfma_f32_16x16x32_bf16 v[148:151], v[164:167], a[20:23], v[148:151]
    v_cvt_pk_bf16_f32 v20, v14, v15
    v_cvt_pk_bf16_f32 v21, v16, v17
    v_cvt_pk_bf16_f32 v128, v120, v121
    v_cvt_pk_bf16_f32 v129, v122, v123
    v_mfma_f32_16x16x32_bf16 v[144:147], v[18:21], a[24:27], v[144:147]
    v_cvt_pk_bf16_f32 v130, v132, v133
    v_cvt_pk_bf16_f32 v131, v134, v135
    v_mfma_f32_16x16x32_bf16 v[148:151], v[18:21], a[28:31], v[148:151]
    s_cbranch_vccnz L_ow6
    buffer_store_dwordx4 v[128:131], v42, s[20:23], s49 offen offset:3072 sc1
L_ox6:
    v_cvt_pk_bf16_f32 v140, v124, v125
    v_cvt_pk_bf16_f32 v141, v126, v127
    v_cvt_pk_bf16_f32 v142, v136, v137
    v_cvt_pk_bf16_f32 v143, v138, v139
    s_cbranch_scc1 L_ow7
    buffer_store_dwordx4 v[140:143], v42, s[20:23], s50 offen offset:3072 sc1
L_ox7:
    s_nop 0
    v_cvt_pk_bf16_f32 v152, v144, v145
    v_cvt_pk_bf16_f32 v153, v146, v147
    s_cbranch_vccnz L_ow8
    buffer_store_dwordx2 v[152:153], v34, s[20:23], s49 offen sc1
L_ox8:
    v_cvt_pk_bf16_f32 v154, v148, v149
    v_cvt_pk_bf16_f32 v155, v150, v151
    s_cbranch_scc1 L_ow9
    buffer_store_dwordx2 v[154:155], v34, s[20:23], s50 offen sc1
L_ox9:
    s_waitcnt vmcnt(0)
    s_mov_b64 exec, 3
    buffer_store_dword v46, v29, s[20:23], 0 offen sc1
    s_mov_b64 exec, 1
    ds_add_u32 v30, v28
    s_mov_b64 exec, -1
    s_cmp_lg_u32 s62, 0
    s_cbranch_scc1 L_cdone
    v_mov_b32 v80, 0
    v_mov_b32 v81, 0
    v_mov_b32 v82, 0
    v_mov_b32 v83, 0
    s_add_u32 s70, s69, 1
    s_and_b32 s70, s70, 7
    s_mul_i32 s70, s70, 4608
    s_add_u32 s85, s70, s45
    s_add_u32 s70, s69, 2
    s_and_b32 s70, s70, 7
    s_mul_i32 s70, s70, 4608
    s_add_u32 s86, s70, s45
    s_add_u32 s70, s69, 3
    s_and_b32 s70, s70, 7
    s_mul_i32 s70, s70, 4608
    s_add_u32 s87, s70, s45
    s_add_u32 s70, s69, 4
    s_and_b32 s70, s70, 7
    s_mul_i32 s70, s70, 4608
    s_add_u32 s88, s70, s45
    s_add_u32 s70, s69, 5
    s_and_b32 s70, s70, 7
    s_mul_i32 s70, s70, 4608
    s_add_u32 s89, s70, s45
    s_add_u32 s70, s69, 6
    s_and_b32 s70, s70, 7
    s_mul_i32 s70, s70, 4608
    s_add_u32 s90, s70, s45
    s_add_u32 s70, s69, 7
    s_and_b32 s70, s70, 7
    s_mul_i32 s70, s70, 4608
    s_add_u32 s91, s70, s45
    s_mov_b32 s4, 0
L_cgo:
    s_sleep 1
    ds_read_b32 v27, v30 offset:4
    s_add_u32 s4, s4, 1
    s_waitcnt lgkmcnt(0)
    v_readfirstlane_b32 s70, v27
    s_cmp_ge_u32 s4, 4194304
    s_cbranch_scc1 L_cgo_done
    s_cmp_lt_u32 s70, 1
    s_cbranch_scc1 L_cgo
L_cgo_done:
    buffer_load_dwordx2 v[50:51], v34, s[20:23], s85 offen sc1
    buffer_load_dwordx2 v[52:53], v34, s[20:23], s86 offen sc1
    buffer_load_dwordx2 v[54:55], v34, s[20:23], s87 offen sc1
    buffer_load_dwordx2 v[56:57], v34, s[20:23], s88 offen sc1
    buffer_load_dwordx2 v[58:59], v34, s[20:23], s89 offen sc1
    buffer_load_dwordx2 v[60:61], v34, s[20:23], s90 offen sc1
    buffer_load_dwordx2 v[62:63], v34, s[20:23], s91 offen sc1
    ds_read_b64 v[48:49], v43
    s_waitcnt lgkmcnt(0)
    v_dot2c_f32_bf16 v80, s47, v48
    v_dot2c_f32_bf16 v81, s48, v48
    v_dot2c_f32_bf16 v82, s47, v49
    v_dot2c_f32_bf16 v83, s48, v49
    s_waitcnt vmcnt(6)
    v_dot2c_f32_bf16 v80, s47, v50
    v_dot2c_f32_bf16 v81, s48, v50
    v_dot2c_f32_bf16 v82, s47, v51
    v_dot2c_f32_bf16 v83, s48, v51
    s_waitcnt vmcnt(5)
    v_dot2c_f32_bf16 v80, s47, v52
    v_dot2c_f32_bf16 v81, s48, v52
    v_dot2c_f32_bf16 v82, s47, v53
    v_dot2c_f32_bf16 v83, s48, v53
    s_waitcnt vmcnt(4)
    v_dot2c_f32_bf16 v80, s47, v54
    v_dot2c_f32_bf16 v81, s48, v54
    v_dot2c_f32_bf16 v82, s47, v55
    v_dot2c_f32_bf16 v83, s48, v55
    s_waitcnt vmcnt(3)
    v_dot2c_f32_bf16 v80, s47, v56
    v_dot2c_f32_bf16 v81, s48, v56
    v_dot2c_f32_bf16 v82, s47, v57
    v_dot2c_f32_bf16 v83, s48, v57
    s_waitcnt vmcnt(2)
    v_dot2c_f32_bf16 v80, s47, v58
    v_dot2c_f32_bf16 v81, s48, v58
    v_dot2c_f32_bf16 v82, s47, v59
    v_dot2c_f32_bf16 v83, s48, v59
    s_waitcnt vmcnt(1)
    v_dot2c_f32_bf16 v80, s47, v60
    v_dot2c_f32_bf16 v81, s48, v60
    v_dot2c_f32_bf16 v82, s47, v61
    v_dot2c_f32_bf16 v83, s48, v61
    s_waitcnt vmcnt(0)
    v_dot2c_f32_bf16 v80, s47, v62
    v_dot2c_f32_bf16 v81, s48, v62
    v_dot2c_f32_bf16 v82, s47, v63
    v_dot2c_f32_bf16 v83, s48, v63
    s_nop 2
    v_cvt_pk_bf16_f32 v48, v80, v81
    v_cvt_pk_bf16_f32 v49, v82, v83
    buffer_store_dwordx2 v[48:49], v32, s[32:35], s46 offen
    s_lshl_b32 s72, s2, 2
    s_add_u32 s72, s72, 15728640
    s_mov_b64 exec, 1
    buffer_store_dword v46, v35, s[20:23], s72 offen offset:0 sc1
    s_mov_b64 exec, -1
L_cdone:
L_end:
    s_endpgm
L_ow0:
    ds_write_b128 v45, v[56:59] offset:0
    s_branch L_ox0
L_ow1:
    ds_write_b128 v45, v[68:71] offset:0
    s_branch L_ox1
L_ow2:
    ds_write_b128 v45, v[80:83] offset:1024
    s_branch L_ox2
L_ow3:
    ds_write_b128 v45, v[92:95] offset:1024
    s_branch L_ox3
L_ow4:
    ds_write_b128 v45, v[104:107] offset:2048
    s_branch L_ox4
L_ow5:
    ds_write_b128 v45, v[116:119] offset:2048
    s_branch L_ox5
L_ow6:
    ds_write_b128 v45, v[128:131] offset:3072
    s_branch L_ox6
L_ow7:
    ds_write_b128 v45, v[140:143] offset:3072
    s_branch L_ox7
L_ow8:
    ds_write_b64 v43, v[152:153]
    s_branch L_ox8
L_ow9:
    ds_write_b64 v43, v[154:155]
    s_branch L_ox9
L_fin:
.section .rodata,"a"
.p2align 6
.amdhsa_kernel concat_heads__gqa_block_cached__mha_block_cached__near_ridge_kernel
  .amdhsa_next_free_vgpr 256
  .amdhsa_next_free_sgpr 102
  .amdhsa_accum_offset 168
  .amdhsa_group_segment_fixed_size 0
  .amdhsa_kernarg_size 104
  .amdhsa_user_sgpr_count 2
  .amdhsa_user_sgpr_kernarg_segment_ptr 1
  .amdhsa_system_sgpr_workgroup_id_x 1
.end_amdhsa_kernel
```
